```python
import torch

def _softmax(x, axis=-1):
    return torch.softmax(x, dim=axis)
def _gelu(x):
    return torch.nn.functional.gelu(x, approximate="tanh")
def _silu(x):
    return torch.nn.functional.silu(x)
def _sigmoid(x):
    return torch.sigmoid(x)
def _layernorm(x, axis=-1, eps=1e-5):
    m = x.mean(dim=axis, keepdim=True)
    v = x.var(dim=axis, keepdim=True, unbiased=False)
    return (x - m) / torch.sqrt(v + eps)
def _scatter_add(tgt, idx, src, axis=0):
    return tgt.clone().index_add_(axis, idx, src)
def _segment_sum(src, seg, n):
    out = torch.zeros((n,) + src.shape[1:], dtype=src.dtype)
    return out.index_add_(0, seg, src)
def _pad(x, pw):
    flat = tuple(v for pair in reversed(pw) for v in pair)
    return torch.nn.functional.pad(x, flat)

kernel_name = 'sequential_preLN__gqa_block_cached__dense_activation_gelu__decode'

def setup_inputs():

    _w = (lambda a: (lambda t: t.to(torch.bfloat16) if t.is_floating_point() else t)(torch.as_tensor(a)))
    def _A_setup():
        B, Sq, D = 2, 1, 512
        Hq, Hkv, Sk, Dh = 32, 8, 32768, 128
        assert Hq % Hkv == 0, (Hq, Hkv)
        return {
            "x": _w((lambda *s: torch.randn(*s, dtype=torch.bfloat16) * 0.1)(B, Sq, D)),
            "k_cache": _w((lambda *s: torch.randn(*s, dtype=torch.bfloat16) * 1.6)(B, Hkv, Sk, Dh)),
            "v_cache": _w((lambda *s: torch.randn(*s, dtype=torch.bfloat16) * 1.6)(B, Hkv, Sk, Dh)),
            "wq": _w((lambda *s: torch.randn(*s, dtype=torch.bfloat16) * 1.6)(D, Hq * Dh) * (D ** -0.5)),
            "wo": _w((lambda *s: torch.randn(*s, dtype=torch.bfloat16) * 1.6)(Hq * Dh, D) * ((Hq * Dh) ** -0.5)),
        }
    _A_in = _A_setup()

    def _B_setup():
        B, S, D, F = 2, 1, 512, 1792
        return {
            "x": _w((lambda *s: torch.randn(*s, dtype=torch.bfloat16) * 0.1)(B, S, D)),
            "w1": _w((lambda *s: torch.randn(*s, dtype=torch.bfloat16) * 3.2)(D, F) * (D ** -0.5)),
            "b1": _w((lambda *s: torch.randn(*s, dtype=torch.bfloat16) * 3.2)(F) * 0.01),
            "w2": _w((lambda *s: torch.randn(*s, dtype=torch.bfloat16) * 3.2)(F, D) * (F ** -0.5)),
            "b2": _w((lambda *s: torch.randn(*s, dtype=torch.bfloat16) * 3.2)(D) * 0.01),
        }
    _B_in = _B_setup()

    return {
        "A_x": _A_in["x"],
        "A_k_cache": _A_in["k_cache"],
        "A_v_cache": _A_in["v_cache"],
        "A_wq": _A_in["wq"],
        "A_wo": _A_in["wo"],
        "B_x": _B_in["x"],
        "B_w1": _B_in["w1"],
        "B_b1": _B_in["b1"],
        "B_w2": _B_in["w2"],
        "B_b2": _B_in["b2"],
    }

def reference(A_x, A_k_cache, A_v_cache, A_wq, A_wo, B_x, B_w1, B_b1, B_w2, B_b2):
    def _A_ref(x, k_cache, v_cache, wq, wo):
        B, Sq, D = x.shape
        Hq, Dh = 32, 128
        Hkv = k_cache.shape[1]
        rep = Hq // Hkv
        q = (lambda x, *d: x.permute(*d))((x @ wq).reshape(B, Sq, Hq, Dh), 0, 2, 1, 3)
        k = (lambda x, n, axis: torch.repeat_interleave(x, n, dim=axis))(k_cache, rep, axis=1)
        v = (lambda x, n, axis: torch.repeat_interleave(x, n, dim=axis))(v_cache, rep, axis=1)
        scores = torch.einsum("bhqd,bhkd->bhqk", q, k) * (Dh ** -0.5)
        p = _softmax(scores, axis=-1)
        o = torch.einsum("bhqk,bhkd->bhqd", p, v)
        return (lambda x, *d: x.permute(*d))(o, 0, 2, 1, 3).reshape(B, Sq, Hq * Dh) @ wo

    def _B_ref(x, w1, b1, w2, b2):
        h = torch.einsum("bsd,df->bsf", x, w1) + b1
        h = _gelu(h)
        return torch.einsum("bsf,fd->bsd", h, w2) + b2

    x = A_x
    h = x + _A_ref(_layernorm(x, axis=-1), A_k_cache, A_v_cache, A_wq, A_wo)
    h2 = h + _B_ref(_layernorm(h, axis=-1), B_w1, B_b1, B_w2, B_b2)
    return h2
```

```asm
; @launch grid=(256,1,1) block=(512,1,1) lds=163840
.amdgcn_target "amdgcn-amd-amdhsa--gfx950"
.text
.globl sequential_preLN__gqa_block_cached__dense_activation_gelu__decode_kernel
.p2align 8
.type sequential_preLN__gqa_block_cached__dense_activation_gelu__decode_kernel,@function
sequential_preLN__gqa_block_cached__dense_activation_gelu__decode_kernel:
    s_cmp_ge_u32 s2, 256
    s_cbranch_scc1 L_end
    s_load_dwordx8 s[4:11], s[0:1], 0
    s_load_dwordx8 s[12:19], s[0:1], 32
    s_load_dwordx8 s[20:27], s[0:1], 64
    s_load_dwordx2 s[28:29], s[0:1], 96
    v_lshrrev_b32 v1, 6, v0
    v_mov_b32 v3, v0
    v_and_b32 v0, 63, v0
    v_readfirstlane_b32 s3, v1
    s_getreg_b32 s60, hwreg(HW_REG_XCC_ID, 0, 4)
    s_lshr_b32 s46, s2, 3
    s_and_b32 s48, s2, 7
    s_and_b32 s44, s46, 15
    s_lshr_b32 s45, s2, 7
    s_lshl_b32 s45, s45, 3
    s_add_u32 s45, s45, s48
    s_lshl_b32 s101, s44, 4
    s_add_u32 s101, s101, s45
    s_lshl_b32 s47, s48, 5
    s_add_u32 s47, s47, s46
    s_mov_b32 s63, 0x3fb8aa3b
    s_lshl_b32 s49, s3, 14
    s_cmp_ge_u32 s44, 7
    s_cselect_b32 s54, 7, 0
    s_sub_u32 s55, s44, s54
    s_cmp_ge_u32 s44, 14
    s_cselect_b32 s54, 7, 0
    s_sub_u32 s55, s55, s54
    s_lshl_b32 s56, 15, s55
    s_sub_u32 s54, 7, s55
    s_lshr_b32 s54, 15, s54
    s_or_b32 s56, s56, s54
    s_and_b32 s56, s56, 0x7f
    s_lshl_b32 s56, s56, 1
    s_min_u32 s54, s45, 8
    s_lshl_b32 s54, 1, s54
    s_sub_u32 s54, s54, 1
    s_and_b32 s54, s56, s54
    s_bcnt1_i32_b32 s57, s54
    s_lshr_b32 s56, s56, s45
    s_and_b32 s58, s56, 1
    s_lshl_b32 s47, s44, 2
    s_add_u32 s47, s47, s57
    s_mul_i32 s82, s45, 14
    s_cmp_gt_u32 s45, 0
    s_cselect_b32 s54, 3, 0
    s_sub_u32 s82, s82, s54
    s_cmp_gt_u32 s45, 8
    s_cselect_b32 s54, 3, 0
    s_sub_u32 s82, s82, s54
    s_cmp_eq_u32 s48, 0
    s_cselect_b32 s81, 11, 14
    s_mul_i32 s54, s57, 1
    s_sub_u32 s82, s82, s54
    s_cmp_lg_u32 s58, 0
    s_cselect_b32 s81, 13, s81
    s_lshl_b32 s53, s44, 23
    s_mov_b32 s55, 0x800000
    s_mov_b32 s52, s55
    s_lshl_b32 s84, s3, 12
    s_lshl_b32 s50, s82, 15
    s_add_u32 s50, s50, s84
    s_add_u32 s51, s50, 32768
    s_mov_b32 s80, 0
    s_mov_b32 s97, 0
    s_mov_b32 s83, 0
    s_cmp_eq_u32 s3, 0
    s_cmp_eq_u32 s48, 0
    s_cselect_b32 s54, 2, 4
    s_cmp_eq_u32 s3, 0
    s_cselect_b32 s85, s54, -1
    s_sub_u32 s54, s81, 3
    s_cmp_eq_u32 s3, 0
    s_cselect_b32 s86, s54, -1
    s_sub_u32 s54, s81, 2
    s_cmp_eq_u32 s3, 0
    s_cselect_b32 s87, s54, 0x7fff
    s_cmp_eq_u32 s48, 0
    s_cselect_b32 s87, 0x7fff, s87
    s_cselect_b32 s86, -1, s86
    s_cmp_eq_u32 s48, 0
    s_mov_b32 s93, -1
    s_mov_b32 s93, s58
    s_mov_b32 s85, -1
    s_mov_b32 s86, -1
    s_mov_b32 s92, 0x3db504f3
    v_lshrrev_b32 v1, 4, v0
    v_and_b32 v2, 15, v0
    v_xor_b32 v10, v1, v2
    v_lshlrev_b32 v10, 4, v10
    v_lshl_add_u32 v4, v1, 8, v10
    v_xor_b32 v5, 64, v4
    v_xor_b32 v6, 128, v4
    v_xor_b32 v7, 192, v4
    v_lshlrev_b32 v10, 1, v1
    v_xor_b32 v10, v10, v2
    v_lshlrev_b32 v10, 4, v10
    v_lshl_add_u32 v8, v1, 8, v10
    v_xor_b32 v9, 128, v8
    s_waitcnt lgkmcnt(0)
    s_load_dword s30, s[28:29], 0
    s_add_u32 s32, s6, s53
    s_addc_u32 s33, s7, 0
    s_mov_b32 s34, s55
    s_mov_b32 s35, 0x20000
    s_add_u32 s36, s8, s53
    s_addc_u32 s37, s9, 0
    s_mov_b32 s38, s55
    s_mov_b32 s39, 0x20000
    s_mov_b32 s40, s10
    s_mov_b32 s41, s11
    s_mov_b32 s42, 0x400000
    s_mov_b32 s43, 0x20000
    v_lshrrev_b32 v14, 3, v0
    v_and_b32 v15, 7, v0
    v_lshlrev_b32 v13, 13, v14
    v_lshl_add_u32 v13, v15, 4, v13
    v_lshlrev_b32 v14, 10, v14
    v_lshl_add_u32 v14, v15, 4, v14
    s_cmp_eq_u32 s48, 0
    s_cbranch_scc1 L_np_tail
    s_cmp_lg_u32 s93, 0
    s_cbranch_scc1 L_qprod
    s_add_u32 m0, s49, 0
    s_nop 0
    buffer_load_dwordx4 v4, s[32:35], s50 offen offset:0 sc1 nt lds
    buffer_load_dwordx4 v5, s[32:35], s50 offen offset:1024 sc1 nt lds
    buffer_load_dwordx4 v6, s[32:35], s50 offen offset:2048 sc1 nt lds
    buffer_load_dwordx4 v7, s[32:35], s50 offen offset:3072 sc1 nt lds
    s_add_u32 m0, s49, 4096
    s_nop 0
    buffer_load_dwordx4 v8, s[36:39], s50 offen offset:0 sc1 nt lds
    buffer_load_dwordx4 v9, s[36:39], s50 offen offset:1024 sc1 nt lds
    buffer_load_dwordx4 v8, s[36:39], s50 offen offset:2048 sc1 nt lds
    buffer_load_dwordx4 v9, s[36:39], s50 offen offset:3072 sc1 nt lds
    s_waitcnt lgkmcnt(0)
    s_add_u32 s30, s30, 1
    s_mul_i32 s31, s30, 0x9E3779B1
    s_branch L_reg_poll
L_np_tail:
    s_waitcnt lgkmcnt(0)
    s_add_u32 s30, s30, 1
    s_mul_i32 s31, s30, 0x9E3779B1
    s_branch L_tail_pro
L_qprod:
    v_bfe_u32 v10, v0, 2, 1
    v_lshlrev_b32 v11, 10, v10
    v_lshrrev_b32 v10, 3, v0
    v_lshl_add_u32 v11, v10, 5, v11
    v_and_b32 v10, 3, v0
    v_lshl_add_u32 v11, v10, 3, v11
    global_load_dwordx2 v[64:65], v11, s[4:5] offset:0
    global_load_dwordx2 v[66:67], v11, s[4:5] offset:256
    global_load_dwordx2 v[68:69], v11, s[4:5] offset:512
    global_load_dwordx2 v[70:71], v11, s[4:5] offset:768
    s_lshl_b32 s54, s3, 19
    s_lshl_b32 s55, s47, 7
    s_add_u32 s54, s54, s55
    s_add_u32 m0, s49, 0
    s_mov_b32 s53, s54
    buffer_load_dwordx4 v13, s[40:43], s53 offen offset:0 sc1 nt lds
    s_add_u32 s53, s53, 64512
    buffer_load_dwordx4 v13, s[40:43], s53 offen offset:1024 sc1 nt lds
    s_add_u32 s53, s53, 64512
    buffer_load_dwordx4 v13, s[40:43], s53 offen offset:2048 sc1 nt lds
    s_add_u32 s53, s53, 64512
    buffer_load_dwordx4 v13, s[40:43], s53 offen offset:3072 sc1 nt lds
    s_add_u32 s54, s54, 262144
    s_add_u32 m0, s49, 4096
    s_mov_b32 s53, s54
    buffer_load_dwordx4 v13, s[40:43], s53 offen offset:0 sc1 nt lds
    s_add_u32 s53, s53, 64512
    buffer_load_dwordx4 v13, s[40:43], s53 offen offset:1024 sc1 nt lds
    s_add_u32 s53, s53, 64512
    buffer_load_dwordx4 v13, s[40:43], s53 offen offset:2048 sc1 nt lds
    s_add_u32 s53, s53, 64512
    buffer_load_dwordx4 v13, s[40:43], s53 offen offset:3072 sc1 nt lds
    s_waitcnt vmcnt(8)
    v_and_b32 v95, 0xffff0000, v71
    v_lshlrev_b32 v94, 16, v71
    v_and_b32 v93, 0xffff0000, v70
    v_lshlrev_b32 v92, 16, v70
    v_and_b32 v91, 0xffff0000, v69
    v_lshlrev_b32 v90, 16, v69
    v_and_b32 v89, 0xffff0000, v68
    v_lshlrev_b32 v88, 16, v68
    v_and_b32 v87, 0xffff0000, v67
    v_lshlrev_b32 v86, 16, v67
    v_and_b32 v85, 0xffff0000, v66
    v_lshlrev_b32 v84, 16, v66
    v_and_b32 v83, 0xffff0000, v65
    v_lshlrev_b32 v82, 16, v65
    v_and_b32 v81, 0xffff0000, v64
    v_lshlrev_b32 v80, 16, v64
    v_bfe_u32 v109, v0, 2, 1
    v_lshlrev_b32 v110, 10, v109
    v_lshrrev_b32 v109, 3, v0
    v_lshl_add_u32 v110, v109, 5, v110
    v_and_b32 v109, 3, v0
    v_lshl_add_u32 v110, v109, 3, v110
    v_add_u32 v110, 147456, v110
    v_pk_add_f32 v[104:105], v[80:81], v[82:83]
    v_pk_mul_f32 v[106:107], v[80:81], v[80:81]
    v_pk_fma_f32 v[106:107], v[82:83], v[82:83], v[106:107]
    v_pk_add_f32 v[104:105], v[104:105], v[84:85]
    v_pk_fma_f32 v[106:107], v[84:85], v[84:85], v[106:107]
    v_pk_add_f32 v[104:105], v[104:105], v[86:87]
    v_pk_fma_f32 v[106:107], v[86:87], v[86:87], v[106:107]
    v_pk_add_f32 v[104:105], v[104:105], v[88:89]
    v_pk_fma_f32 v[106:107], v[88:89], v[88:89], v[106:107]
    v_pk_add_f32 v[104:105], v[104:105], v[90:91]
    v_pk_fma_f32 v[106:107], v[90:91], v[90:91], v[106:107]
    v_pk_add_f32 v[104:105], v[104:105], v[92:93]
    v_pk_fma_f32 v[106:107], v[92:93], v[92:93], v[106:107]
    v_pk_add_f32 v[104:105], v[104:105], v[94:95]
    v_pk_fma_f32 v[106:107], v[94:95], v[94:95], v[106:107]
    v_add_f32 v104, v104, v105
    v_add_f32 v106, v106, v107
    s_nop 0
    v_add_f32_dpp v104, v104, v104 quad_perm:[1,0,3,2] row_mask:0xf bank_mask:0xf
    v_add_f32_dpp v106, v106, v106 quad_perm:[1,0,3,2] row_mask:0xf bank_mask:0xf
    s_nop 0
    v_add_f32_dpp v104, v104, v104 quad_perm:[2,3,0,1] row_mask:0xf bank_mask:0xf
    v_add_f32_dpp v106, v106, v106 quad_perm:[2,3,0,1] row_mask:0xf bank_mask:0xf
    s_nop 0
    v_add_f32_dpp v104, v104, v104 row_ror:8 row_mask:0xf bank_mask:0xf
    v_add_f32_dpp v106, v106, v106 row_ror:8 row_mask:0xf bank_mask:0xf
    v_mov_b32 v105, v104
    v_mov_b32 v107, v106
    s_nop 0
    v_permlane16_swap_b32 v104, v105
    v_permlane16_swap_b32 v106, v107
    v_add_f32 v104, v104, v105
    v_add_f32 v106, v106, v107
    v_mov_b32 v105, v104
    v_mov_b32 v107, v106
    s_nop 0
    v_permlane32_swap_b32 v104, v105
    v_permlane32_swap_b32 v106, v107
    v_add_f32 v104, v104, v105
    v_add_f32 v106, v106, v107
    v_mul_f32 v108, 0x3b000000, v104
    v_mul_f32 v106, 0x3b000000, v106
    v_fma_f32 v104, -v108, v108, v106
    v_max_f32 v104, 0, v104
    v_cvt_pk_bf16_f32 v104, v104, v104
    v_and_b32 v104, 0xffff0000, v104
    v_add_f32 v104, 0x3727c5ac, v104
    v_cvt_pk_bf16_f32 v104, v104, v104
    v_and_b32 v104, 0xffff0000, v104
    v_sqrt_f32 v104, v104
    v_cvt_pk_bf16_f32 v108, v108, v108
    v_and_b32 v108, 0xffff0000, v108
    v_cvt_pk_bf16_f32 v104, v104, v104
    v_and_b32 v104, 0xffff0000, v104
    v_rcp_f32 v104, v104
    v_pk_add_f32 v[80:81], v[80:81], v[108:109] op_sel_hi:[1,0] neg_lo:[0,1] neg_hi:[0,1]
    v_pk_add_f32 v[82:83], v[82:83], v[108:109] op_sel_hi:[1,0] neg_lo:[0,1] neg_hi:[0,1]
    v_pk_add_f32 v[84:85], v[84:85], v[108:109] op_sel_hi:[1,0] neg_lo:[0,1] neg_hi:[0,1]
    v_pk_add_f32 v[86:87], v[86:87], v[108:109] op_sel_hi:[1,0] neg_lo:[0,1] neg_hi:[0,1]
    v_pk_add_f32 v[88:89], v[88:89], v[108:109] op_sel_hi:[1,0] neg_lo:[0,1] neg_hi:[0,1]
    v_pk_add_f32 v[90:91], v[90:91], v[108:109] op_sel_hi:[1,0] neg_lo:[0,1] neg_hi:[0,1]
    v_pk_add_f32 v[92:93], v[92:93], v[108:109] op_sel_hi:[1,0] neg_lo:[0,1] neg_hi:[0,1]
    v_pk_add_f32 v[94:95], v[94:95], v[108:109] op_sel_hi:[1,0] neg_lo:[0,1] neg_hi:[0,1]
    v_cvt_pk_bf16_f32 v106, v80, v81
    v_and_b32 v81, 0xffff0000, v106
    v_lshlrev_b32 v80, 16, v106
    v_cvt_pk_bf16_f32 v106, v82, v83
    v_and_b32 v83, 0xffff0000, v106
    v_lshlrev_b32 v82, 16, v106
    v_cvt_pk_bf16_f32 v106, v84, v85
    v_and_b32 v85, 0xffff0000, v106
    v_lshlrev_b32 v84, 16, v106
    v_cvt_pk_bf16_f32 v106, v86, v87
    v_and_b32 v87, 0xffff0000, v106
    v_lshlrev_b32 v86, 16, v106
    v_cvt_pk_bf16_f32 v106, v88, v89
    v_and_b32 v89, 0xffff0000, v106
    v_lshlrev_b32 v88, 16, v106
    v_cvt_pk_bf16_f32 v106, v90, v91
    v_and_b32 v91, 0xffff0000, v106
    v_lshlrev_b32 v90, 16, v106
    v_cvt_pk_bf16_f32 v106, v92, v93
    v_and_b32 v93, 0xffff0000, v106
    v_lshlrev_b32 v92, 16, v106
    v_cvt_pk_bf16_f32 v106, v94, v95
    v_and_b32 v95, 0xffff0000, v106
    v_lshlrev_b32 v94, 16, v106
    v_pk_mul_f32 v[80:81], v[80:81], v[104:105] op_sel_hi:[1,0]
    v_pk_mul_f32 v[82:83], v[82:83], v[104:105] op_sel_hi:[1,0]
    v_pk_mul_f32 v[84:85], v[84:85], v[104:105] op_sel_hi:[1,0]
    v_pk_mul_f32 v[86:87], v[86:87], v[104:105] op_sel_hi:[1,0]
    v_pk_mul_f32 v[88:89], v[88:89], v[104:105] op_sel_hi:[1,0]
    v_pk_mul_f32 v[90:91], v[90:91], v[104:105] op_sel_hi:[1,0]
    v_pk_mul_f32 v[92:93], v[92:93], v[104:105] op_sel_hi:[1,0]
    v_pk_mul_f32 v[94:95], v[94:95], v[104:105] op_sel_hi:[1,0]
    v_cvt_pk_bf16_f32 v80, v80, v81
    v_cvt_pk_bf16_f32 v81, v82, v83
    ds_write_b64 v110, v[80:81] offset:0
    v_cvt_pk_bf16_f32 v84, v84, v85
    v_cvt_pk_bf16_f32 v85, v86, v87
    ds_write_b64 v110, v[84:85] offset:256
    v_cvt_pk_bf16_f32 v88, v88, v89
    v_cvt_pk_bf16_f32 v89, v90, v91
    ds_write_b64 v110, v[88:89] offset:512
    v_cvt_pk_bf16_f32 v92, v92, v93
    v_cvt_pk_bf16_f32 v93, v94, v95
    ds_write_b64 v110, v[92:93] offset:768
    v_lshrrev_b32 v1, 4, v0
    v_and_b32 v2, 1, v0
    v_lshlrev_b32 v10, 10, v2
    v_lshl_add_u32 v10, v1, 4, v10
    s_lshl_b32 s53, s3, 7
    s_add_u32 s53, s53, 147456
    v_add_u32 v10, s53, v10
    v_bfe_u32 v11, v0, 2, 2
    v_lshl_add_u32 v11, v1, 3, v11
    v_and_b32 v2, 3, v0
    v_lshlrev_b32 v2, 3, v2
    v_lshl_add_u32 v11, v11, 7, v2
    v_add_u32 v11, s49, v11
    s_waitcnt lgkmcnt(0)
    ds_read_b128 v[64:67], v10
    ds_read_b128 v[68:71], v10 offset:64
    s_waitcnt vmcnt(0)
    ds_read_b64_tr_b16 v[16:17], v11 offset:0
    ds_read_b64_tr_b16 v[18:19], v11 offset:512
    ds_read_b64_tr_b16 v[20:21], v11 offset:32
    ds_read_b64_tr_b16 v[22:23], v11 offset:544
    ds_read_b64_tr_b16 v[24:25], v11 offset:64
    ds_read_b64_tr_b16 v[26:27], v11 offset:576
    ds_read_b64_tr_b16 v[28:29], v11 offset:96
    ds_read_b64_tr_b16 v[30:31], v11 offset:608
    ds_read_b64_tr_b16 v[32:33], v11 offset:4096
    ds_read_b64_tr_b16 v[34:35], v11 offset:4608
    ds_read_b64_tr_b16 v[36:37], v11 offset:4128
    ds_read_b64_tr_b16 v[38:39], v11 offset:4640
    ds_read_b64_tr_b16 v[40:41], v11 offset:4160
    ds_read_b64_tr_b16 v[42:43], v11 offset:4672
    ds_read_b64_tr_b16 v[44:45], v11 offset:4192
    ds_read_b64_tr_b16 v[46:47], v11 offset:4704
    v_lshlrev_b32 v10, 3, v0
    s_lshl_b32 s53, s3, 9
    s_add_u32 s53, s53, 131072
    v_add_u32 v10, s53, v10
    s_waitcnt lgkmcnt(0)
    v_mfma_f32_16x16x32_bf16 v[80:83], v[64:67], v[16:19], 0
    v_mfma_f32_16x16x32_bf16 v[84:87], v[64:67], v[20:23], 0
    v_mfma_f32_16x16x32_bf16 v[88:91], v[64:67], v[24:27], 0
    v_mfma_f32_16x16x32_bf16 v[92:95], v[64:67], v[28:31], 0
    v_mfma_f32_16x16x32_bf16 v[80:83], v[68:71], v[32:35], v[80:83]
    v_mfma_f32_16x16x32_bf16 v[84:87], v[68:71], v[36:39], v[84:87]
    v_mfma_f32_16x16x32_bf16 v[88:91], v[68:71], v[40:43], v[88:91]
    v_mfma_f32_16x16x32_bf16 v[92:95], v[68:71], v[44:47], v[92:95]
    s_nop 5
    v_mov_b32_dpp v80, v84 quad_perm:[0,1,2,3] row_mask:0x2 bank_mask:0xf
    v_mov_b32_dpp v81, v85 quad_perm:[0,1,2,3] row_mask:0x2 bank_mask:0xf
    s_nop 0
    v_mov_b32_dpp v80, v88 quad_perm:[0,1,2,3] row_mask:0x4 bank_mask:0xf
    v_mov_b32_dpp v81, v89 quad_perm:[0,1,2,3] row_mask:0x4 bank_mask:0xf
    s_nop 0
    v_mov_b32_dpp v80, v92 quad_perm:[0,1,2,3] row_mask:0x8 bank_mask:0xf
    v_mov_b32_dpp v81, v93 quad_perm:[0,1,2,3] row_mask:0x8 bank_mask:0xf
    ds_write_b64 v10, v[80:81]
    s_waitcnt lgkmcnt(0)
    s_barrier
    s_waitcnt lgkmcnt(0)
    s_add_u32 s30, s30, 1
    s_mul_i32 s31, s30, 0x9E3779B1
    s_cmp_lg_u32 s3, 0
    s_cbranch_scc1 L_noqpub
    v_lshlrev_b32 v10, 3, v0
    v_add_u32 v11, 131072, v10
    ds_read_b64 v[64:65], v11 offset:0
    ds_read_b64 v[66:67], v11 offset:512
    ds_read_b64 v[68:69], v11 offset:1024
    ds_read_b64 v[70:71], v11 offset:1536
    ds_read_b64 v[72:73], v11 offset:2048
    ds_read_b64 v[74:75], v11 offset:2560
    ds_read_b64 v[76:77], v11 offset:3072
    ds_read_b64 v[78:79], v11 offset:3584
    s_lshl_b32 s53, s47, 9
    s_add_u32 s53, s53, 4096
    v_add_u32 v11, s53, v10
    s_waitcnt lgkmcnt(0)
    v_add_f32 v64, v64, v66
    v_add_f32 v65, v65, v67
    v_add_f32 v64, v64, v68
    v_add_f32 v65, v65, v69
    v_add_f32 v64, v64, v70
    v_add_f32 v65, v65, v71
    v_add_f32 v64, v64, v72
    v_add_f32 v65, v65, v73
    v_add_f32 v64, v64, v74
    v_add_f32 v65, v65, v75
    v_add_f32 v64, v64, v76
    v_add_f32 v65, v65, v77
    v_add_f32 v64, v64, v78
    v_add_f32 v65, v65, v79
    v_cvt_pk_bf16_f32 v64, v64, v65
    v_mov_b32 v65, s31
    global_store_dwordx2 v11, v[64:65], s[28:29] sc1
L_noqpub:
    s_add_u32 m0, s49, 0
    s_nop 0
    buffer_load_dwordx4 v4, s[32:35], s50 offen offset:0 sc1 nt lds
    buffer_load_dwordx4 v5, s[32:35], s50 offen offset:1024 sc1 nt lds
    buffer_load_dwordx4 v6, s[32:35], s50 offen offset:2048 sc1 nt lds
    buffer_load_dwordx4 v7, s[32:35], s50 offen offset:3072 sc1 nt lds
    s_add_u32 m0, s49, 4096
    s_nop 0
    buffer_load_dwordx4 v8, s[36:39], s50 offen offset:0 sc1 nt lds
    buffer_load_dwordx4 v9, s[36:39], s50 offen offset:1024 sc1 nt lds
    buffer_load_dwordx4 v8, s[36:39], s50 offen offset:2048 sc1 nt lds
    buffer_load_dwordx4 v9, s[36:39], s50 offen offset:3072 sc1 nt lds
    s_branch L_reg_poll
L_reg_poll:
    v_lshrrev_b32 v1, 4, v0
    v_and_b32 v2, 15, v0
    v_xor_b32 v10, v1, v2
    v_lshlrev_b32 v10, 4, v10
    v_lshl_add_u32 v10, v2, 8, v10
    v_add_u32 v112, s49, v10
    v_xor_b32 v113, 64, v112
    v_xor_b32 v114, 128, v112
    v_xor_b32 v115, 192, v112
    v_lshrrev_b32 v10, 2, v2
    v_lshl_add_u32 v10, v1, 2, v10
    v_and_b32 v11, 7, v10
    v_lshlrev_b32 v11, 5, v11
    v_lshl_add_u32 v11, v10, 8, v11
    v_and_b32 v10, 3, v2
    v_lshl_add_u32 v11, v10, 3, v11
    s_add_u32 s53, s49, 4096
    v_add_u32 v116, s53, v11
    v_xor_b32 v117, 32, v116
    v_xor_b32 v118, 64, v116
    v_xor_b32 v119, 96, v116
    v_xor_b32 v120, 128, v116
    v_xor_b32 v121, 160, v116
    v_xor_b32 v122, 192, v116
    v_xor_b32 v123, 224, v116
    v_mov_b32 v32, 0
    v_mov_b32 v33, 0
    v_mov_b32 v34, 0
    v_mov_b32 v35, 0
    v_mov_b32 v36, 0
    v_mov_b32 v37, 0
    v_mov_b32 v38, 0
    v_mov_b32 v39, 0
    v_mov_b32 v40, 0
    v_mov_b32 v41, 0
    v_mov_b32 v42, 0
    v_mov_b32 v43, 0
    v_mov_b32 v44, 0
    v_mov_b32 v45, 0
    v_mov_b32 v46, 0
    v_mov_b32 v47, 0
    v_mov_b32 v48, 0
    v_mov_b32 v49, 0
    v_mov_b32 v50, 0
    v_mov_b32 v51, 0
    v_mov_b32 v52, 0
    v_mov_b32 v53, 0
    v_mov_b32 v54, 0
    v_mov_b32 v55, 0
    v_mov_b32 v56, 0
    v_mov_b32 v57, 0
    v_mov_b32 v58, 0
    v_mov_b32 v59, 0
    v_mov_b32 v60, 0
    v_mov_b32 v61, 0
    v_mov_b32 v62, 0
    v_mov_b32 v63, 0
    v_mov_b32 v102, 0xff61b1e6
    v_mov_b32 v103, 0
    v_mul_f32 v104, s63, v102
    v_lshrrev_b32 v1, 4, v0
    v_and_b32 v2, 15, v0
    v_and_b32 v105, 3, v2
    v_mul_u32_u24 v10, 528, v105
    v_lshrrev_b32 v105, 2, v2
    v_lshl_add_u32 v10, v105, 6, v10
    v_lshl_add_u32 v10, v1, 4, v10
    s_mul_i32 s53, s3, 2112
    s_add_u32 s53, s53, 131072
    v_add_u32 v10, s53, v10
    v_lshlrev_b32 v11, 6, v2
    s_lshl_b32 s53, s3, 3
    s_add_u32 s53, s53, 157696
    v_add_u32 v11, s53, v11
    s_lshl_b32 s53, s101, 11
    s_add_u32 s53, s53, 65536
    v_lshl_add_u32 v12, v3, 2, s53
    s_lshr_b32 s53, s3, 1
    s_mul_i32 s53, s53, 528
    s_add_u32 s53, s53, 131072
    v_and_b32 v13, 127, v3
    v_lshl_add_u32 v13, v13, 2, s53
    s_and_b32 s53, s30, 0xff
    v_mov_b32 v14, s53
    s_movk_i32 s96, 0xff
    s_waitcnt vmcnt(4)
    ds_read_b128 a[0:3], v112 offset:0
    ds_read_b128 a[4:7], v113 offset:0
    ds_read_b128 a[8:11], v114 offset:0
    ds_read_b128 a[12:15], v115 offset:0
    s_waitcnt lgkmcnt(0)
    s_add_u32 m0, s49, 8192
    s_nop 0
    buffer_load_dwordx4 v4, s[32:35], s51 offen offset:0 sc1 nt lds
    buffer_load_dwordx4 v5, s[32:35], s51 offen offset:1024 sc1 nt lds
    buffer_load_dwordx4 v6, s[32:35], s51 offen offset:2048 sc1 nt lds
    buffer_load_dwordx4 v7, s[32:35], s51 offen offset:3072 sc1 nt lds
    s_waitcnt vmcnt(4)
    ds_read_b64_tr_b16 a[16:17], v116 offset:0
    ds_read_b64_tr_b16 a[18:19], v117 offset:0
    ds_read_b64_tr_b16 a[20:21], v118 offset:0
    ds_read_b64_tr_b16 a[22:23], v119 offset:0
    ds_read_b64_tr_b16 a[24:25], v120 offset:0
    ds_read_b64_tr_b16 a[26:27], v121 offset:0
    ds_read_b64_tr_b16 a[28:29], v122 offset:0
    ds_read_b64_tr_b16 a[30:31], v123 offset:0
    s_waitcnt lgkmcnt(0)
    s_add_u32 m0, s49, 12288
    s_nop 0
    buffer_load_dwordx4 v8, s[36:39], s51 offen offset:0 sc1 nt lds
    buffer_load_dwordx4 v9, s[36:39], s51 offen offset:1024 sc1 nt lds
    buffer_load_dwordx4 v8, s[36:39], s51 offen offset:2048 sc1 nt lds
    buffer_load_dwordx4 v9, s[36:39], s51 offen offset:3072 sc1 nt lds
    s_waitcnt vmcnt(4)
    ds_read_b128 a[32:35], v112 offset:8192
    ds_read_b128 a[36:39], v113 offset:8192
    ds_read_b128 a[40:43], v114 offset:8192
    ds_read_b128 a[44:47], v115 offset:8192
    s_waitcnt lgkmcnt(0)
    s_add_u32 s50, s50, 65536
    s_add_u32 m0, s49, 0
    s_nop 0
    buffer_load_dwordx4 v4, s[32:35], s50 offen offset:0 sc1 nt lds
    buffer_load_dwordx4 v5, s[32:35], s50 offen offset:1024 sc1 nt lds
    buffer_load_dwordx4 v6, s[32:35], s50 offen offset:2048 sc1 nt lds
    buffer_load_dwordx4 v7, s[32:35], s50 offen offset:3072 sc1 nt lds
    s_waitcnt vmcnt(4)
    ds_read_b64_tr_b16 a[48:49], v116 offset:8192
    ds_read_b64_tr_b16 a[50:51], v117 offset:8192
    ds_read_b64_tr_b16 a[52:53], v118 offset:8192
    ds_read_b64_tr_b16 a[54:55], v119 offset:8192
    ds_read_b64_tr_b16 a[56:57], v120 offset:8192
    ds_read_b64_tr_b16 a[58:59], v121 offset:8192
    ds_read_b64_tr_b16 a[60:61], v122 offset:8192
    ds_read_b64_tr_b16 a[62:63], v123 offset:8192
    s_waitcnt lgkmcnt(0)
    s_add_u32 m0, s49, 4096
    s_nop 0
    buffer_load_dwordx4 v8, s[36:39], s50 offen offset:0 sc1 nt lds
    buffer_load_dwordx4 v9, s[36:39], s50 offen offset:1024 sc1 nt lds
    buffer_load_dwordx4 v8, s[36:39], s50 offen offset:2048 sc1 nt lds
    buffer_load_dwordx4 v9, s[36:39], s50 offen offset:3072 sc1 nt lds
    s_cmp_lg_u32 s3, 0
    s_cbranch_scc1 L_reg_other
    s_and_b32 s54, s44, 7
    s_lshl_b32 s54, s54, 12
    s_add_u32 s53, s54, 4096
    v_lshl_add_u32 v111, v0, 4, s53
    s_lshr_b32 s54, s44, 3
    s_mul_i32 s54, s54, 0x02020202
    s_add_u32 s59, s54, 0x05040100
    s_mov_b32 s61, 0
    global_load_dwordx4 v[64:67], v111, s[28:29] offset:0 sc1
    global_load_dwordx4 v[68:71], v111, s[28:29] offset:1024 sc1
    global_load_dwordx4 v[72:75], v111, s[28:29] offset:2048 sc1
    global_load_dwordx4 v[76:79], v111, s[28:29] offset:3072 sc1
    s_waitcnt vmcnt(8)
    s_add_u32 s51, s51, 65536
    s_add_u32 m0, s49, 8192
    s_nop 0
    buffer_load_dwordx4 v4, s[32:35], s51 offen offset:0 sc1 nt lds
    buffer_load_dwordx4 v5, s[32:35], s51 offen offset:1024 sc1 nt lds
    buffer_load_dwordx4 v6, s[32:35], s51 offen offset:2048 sc1 nt lds
    buffer_load_dwordx4 v7, s[32:35], s51 offen offset:3072 sc1 nt lds
    global_load_dwordx4 a[80:83], v111, s[28:29] offset:0 sc1
    global_load_dwordx4 a[84:87], v111, s[28:29] offset:1024 sc1
    global_load_dwordx4 a[88:91], v111, s[28:29] offset:2048 sc1
    global_load_dwordx4 a[92:95], v111, s[28:29] offset:3072 sc1
    s_waitcnt vmcnt(12)
    s_add_u32 m0, s49, 12288
    s_nop 0
    buffer_load_dwordx4 v8, s[36:39], s51 offen offset:0 sc1 nt lds
    buffer_load_dwordx4 v9, s[36:39], s51 offen offset:1024 sc1 nt lds
    buffer_load_dwordx4 v8, s[36:39], s51 offen offset:2048 sc1 nt lds
    buffer_load_dwordx4 v9, s[36:39], s51 offen offset:3072 sc1 nt lds
    global_load_dwordx4 a[64:67], v111, s[28:29] offset:0 sc1
    global_load_dwordx4 a[68:71], v111, s[28:29] offset:1024 sc1
    global_load_dwordx4 a[72:75], v111, s[28:29] offset:2048 sc1
    global_load_dwordx4 a[76:79], v111, s[28:29] offset:3072 sc1
    s_waitcnt vmcnt(16)
    v_xor_b32 v96, s31, v65
    v_xor_b32 v97, s31, v67
    v_or_b32 v96, v96, v97
    v_xor_b32 v97, s31, v69
    v_or_b32 v96, v96, v97
    v_xor_b32 v97, s31, v71
    v_or_b32 v96, v96, v97
    v_xor_b32 v97, s31, v73
    v_or_b32 v96, v96, v97
    v_xor_b32 v97, s31, v75
    v_or_b32 v96, v96, v97
    v_xor_b32 v97, s31, v77
    v_or_b32 v96, v96, v97
    v_xor_b32 v97, s31, v79
    v_or_b32 v96, v96, v97
    v_cmp_ne_u32 vcc, 0, v96
    s_cbranch_vccz L_qok_r
    s_waitcnt vmcnt(8)
    v_accvgpr_read_b32 v64, a80
    v_accvgpr_read_b32 v65, a81
    v_accvgpr_read_b32 v66, a82
    v_accvgpr_read_b32 v67, a83
    v_accvgpr_read_b32 v68, a84
    v_accvgpr_read_b32 v69, a85
    v_accvgpr_read_b32 v70, a86
    v_accvgpr_read_b32 v71, a87
    v_accvgpr_read_b32 v72, a88
    v_accvgpr_read_b32 v73, a89
    v_accvgpr_read_b32 v74, a90
    v_accvgpr_read_b32 v75, a91
    v_accvgpr_read_b32 v76, a92
    v_accvgpr_read_b32 v77, a93
    v_accvgpr_read_b32 v78, a94
    v_accvgpr_read_b32 v79, a95
    v_xor_b32 v96, s31, v65
    v_xor_b32 v97, s31, v67
    v_or_b32 v96, v96, v97
    v_xor_b32 v97, s31, v69
    v_or_b32 v96, v96, v97
    v_xor_b32 v97, s31, v71
    v_or_b32 v96, v96, v97
    v_xor_b32 v97, s31, v73
    v_or_b32 v96, v96, v97
    v_xor_b32 v97, s31, v75
    v_or_b32 v96, v96, v97
    v_xor_b32 v97, s31, v77
    v_or_b32 v96, v96, v97
    v_xor_b32 v97, s31, v79
    v_or_b32 v96, v96, v97
    v_cmp_ne_u32 vcc, 0, v96
    s_cbranch_vccz L_qok_r
    s_waitcnt vmcnt(0)
    v_accvgpr_read_b32 v64, a64
    v_accvgpr_read_b32 v65, a65
    v_accvgpr_read_b32 v66, a66
    v_accvgpr_read_b32 v67, a67
    v_accvgpr_read_b32 v68, a68
    v_accvgpr_read_b32 v69, a69
    v_accvgpr_read_b32 v70, a70
    v_accvgpr_read_b32 v71, a71
    v_accvgpr_read_b32 v72, a72
    v_accvgpr_read_b32 v73, a73
    v_accvgpr_read_b32 v74, a74
    v_accvgpr_read_b32 v75, a75
    v_accvgpr_read_b32 v76, a76
    v_accvgpr_read_b32 v77, a77
    v_accvgpr_read_b32 v78, a78
    v_accvgpr_read_b32 v79, a79
    v_xor_b32 v96, s31, v65
    v_xor_b32 v97, s31, v67
    v_or_b32 v96, v96, v97
    v_xor_b32 v97, s31, v69
    v_or_b32 v96, v96, v97
    v_xor_b32 v97, s31, v71
    v_or_b32 v96, v96, v97
    v_xor_b32 v97, s31, v73
    v_or_b32 v96, v96, v97
    v_xor_b32 v97, s31, v75
    v_or_b32 v96, v96, v97
    v_xor_b32 v97, s31, v77
    v_or_b32 v96, v96, v97
    v_xor_b32 v97, s31, v79
    v_or_b32 v96, v96, v97
    v_cmp_ne_u32 vcc, 0, v96
    s_cbranch_vccz L_qok_r
L_qretry_r:
    global_load_dwordx4 v[64:67], v111, s[28:29] offset:0 sc1
    global_load_dwordx4 v[68:71], v111, s[28:29] offset:1024 sc1
    global_load_dwordx4 v[72:75], v111, s[28:29] offset:2048 sc1
    global_load_dwordx4 v[76:79], v111, s[28:29] offset:3072 sc1
    s_add_u32 s61, s61, 1
    s_cmp_gt_u32 s61, 400000
    s_cbranch_scc1 L_qok_r
    s_waitcnt vmcnt(0)
    v_xor_b32 v96, s31, v65
    v_xor_b32 v97, s31, v67
    v_or_b32 v96, v96, v97
    v_xor_b32 v97, s31, v69
    v_or_b32 v96, v96, v97
    v_xor_b32 v97, s31, v71
    v_or_b32 v96, v96, v97
    v_xor_b32 v97, s31, v73
    v_or_b32 v96, v96, v97
    v_xor_b32 v97, s31, v75
    v_or_b32 v96, v96, v97
    v_xor_b32 v97, s31, v77
    v_or_b32 v96, v96, v97
    v_xor_b32 v97, s31, v79
    v_or_b32 v96, v96, v97
    v_cmp_ne_u32 vcc, 0, v96
    s_cbranch_vccz L_qok_r
    s_branch L_qretry_r
L_qok_r:
    v_lshlrev_b32 v97, 2, v0
    v_add_u32 v97, 156672, v97
    v_perm_b32 v64, v66, v64, s59
    ds_write_b32 v97, v64 offset:0
    v_perm_b32 v68, v70, v68, s59
    ds_write_b32 v97, v68 offset:256
    v_perm_b32 v72, v74, v72, s59
    ds_write_b32 v97, v72 offset:512
    v_perm_b32 v76, v78, v76, s59
    ds_write_b32 v97, v76 offset:768
    s_waitcnt lgkmcnt(0)
    s_barrier
    s_branch L_reg_join
L_reg_other:
    s_waitcnt vmcnt(4)
    s_add_u32 s51, s51, 65536
    s_add_u32 m0, s49, 8192
    s_nop 0
    buffer_load_dwordx4 v4, s[32:35], s51 offen offset:0 sc1 nt lds
    buffer_load_dwordx4 v5, s[32:35], s51 offen offset:1024 sc1 nt lds
    buffer_load_dwordx4 v6, s[32:35], s51 offen offset:2048 sc1 nt lds
    buffer_load_dwordx4 v7, s[32:35], s51 offen offset:3072 sc1 nt lds
    s_waitcnt vmcnt(4)
    s_add_u32 m0, s49, 12288
    s_nop 0
    buffer_load_dwordx4 v8, s[36:39], s51 offen offset:0 sc1 nt lds
    buffer_load_dwordx4 v9, s[36:39], s51 offen offset:1024 sc1 nt lds
    buffer_load_dwordx4 v8, s[36:39], s51 offen offset:2048 sc1 nt lds
    buffer_load_dwordx4 v9, s[36:39], s51 offen offset:3072 sc1 nt lds
    s_barrier
L_reg_join:
    v_lshrrev_b32 v1, 4, v0
    v_and_b32 v2, 3, v0
    v_lshlrev_b32 v2, 8, v2
    v_lshl_add_u32 v2, v1, 4, v2
    v_add_u32 v2, 156672, v2
    ds_read_b128 v[16:19], v2 offset:0
    ds_read_b128 v[20:23], v2 offset:64
    ds_read_b128 v[24:27], v2 offset:128
    ds_read_b128 v[28:31], v2 offset:192
    s_waitcnt lgkmcnt(0)
    s_mov_b32 s97, 1
    s_mov_b32 s80, 2
    v_mov_b32 v127, 0
    s_branch L_loop_entry
L_tail_pro:
    s_cmp_lg_u32 s3, 7
    s_cbranch_scc1 L_noxcc
    s_and_b32 s53, s31, 0xfffffff0
    s_or_b32 s53, s53, s60
    v_mov_b32 v10, s53
    s_lshl_b32 s53, s46, 2
    s_add_u32 s53, s53, 1019904
    v_mov_b32 v11, s53
    s_mov_b64 exec, 1
    global_store_dword v11, v10, s[28:29] sc1
    s_mov_b64 exec, -1
L_noxcc:
    s_mov_b32 s40, s12
    s_mov_b32 s41, s13
    s_mov_b32 s42, 0x400000
    s_mov_b32 s43, 0x20000
    s_lshl_b32 s54, s46, 17
    s_lshl_b32 s55, s3, 7
    s_add_u32 s54, s54, s55
    s_add_u32 m0, s49, 0
    s_mov_b32 s53, s54
    buffer_load_dwordx4 v14, s[40:43], s53 offen offset:0 sc1 nt lds
    s_add_u32 s53, s53, 7168
    buffer_load_dwordx4 v14, s[40:43], s53 offen offset:1024 sc1 nt lds
    s_add_u32 s53, s53, 7168
    buffer_load_dwordx4 v14, s[40:43], s53 offen offset:2048 sc1 nt lds
    s_add_u32 s53, s53, 7168
    buffer_load_dwordx4 v14, s[40:43], s53 offen offset:3072 sc1 nt lds
    s_add_u32 s54, s54, 32768
    s_add_u32 m0, s49, 4096
    s_mov_b32 s53, s54
    buffer_load_dwordx4 v14, s[40:43], s53 offen offset:0 sc1 nt lds
    s_add_u32 s53, s53, 7168
    buffer_load_dwordx4 v14, s[40:43], s53 offen offset:1024 sc1 nt lds
    s_add_u32 s53, s53, 7168
    buffer_load_dwordx4 v14, s[40:43], s53 offen offset:2048 sc1 nt lds
    s_add_u32 s53, s53, 7168
    buffer_load_dwordx4 v14, s[40:43], s53 offen offset:3072 sc1 nt lds
    s_add_u32 s54, s54, 32768
    s_add_u32 m0, s49, 8192
    s_mov_b32 s53, s54
    buffer_load_dwordx4 v14, s[40:43], s53 offen offset:0 sc1 nt lds
    s_add_u32 s53, s53, 7168
    buffer_load_dwordx4 v14, s[40:43], s53 offen offset:1024 sc1 nt lds
    s_add_u32 s53, s53, 7168
    buffer_load_dwordx4 v14, s[40:43], s53 offen offset:2048 sc1 nt lds
    s_add_u32 s53, s53, 7168
    buffer_load_dwordx4 v14, s[40:43], s53 offen offset:3072 sc1 nt lds
    s_add_u32 s54, s54, 32768
    s_add_u32 m0, s49, 12288
    s_mov_b32 s53, s54
    buffer_load_dwordx4 v14, s[40:43], s53 offen offset:0 sc1 nt lds
    s_add_u32 s53, s53, 7168
    buffer_load_dwordx4 v14, s[40:43], s53 offen offset:1024 sc1 nt lds
    s_add_u32 s53, s53, 7168
    buffer_load_dwordx4 v14, s[40:43], s53 offen offset:2048 sc1 nt lds
    s_add_u32 s53, s53, 7168
    buffer_load_dwordx4 v14, s[40:43], s53 offen offset:3072 sc1 nt lds
    v_bfe_u32 v1, v0, 4, 1
    v_and_b32 v2, 7, v0
    v_lshrrev_b32 v10, 5, v0
    v_lshl_add_u32 v2, v2, 1, v10
    s_lshl_b32 s53, s46, 4
    v_add_u32 v2, s53, v2
    v_lshlrev_b32 v10, 1, v2
    v_lshl_add_u32 v11, v1, 10, v10
    global_load_ushort v124, v11, s[4:5]
    global_load_ushort v125, v10, s[22:23]
    v_and_b32 v2, 15, v0
    s_lshl_b32 s53, s46, 6
    s_lshl_b32 s54, s3, 4
    s_add_u32 s53, s53, s54
    s_min_u32 s53, s53, 1776
    v_add_u32 v2, s53, v2
    v_lshlrev_b32 v2, 1, v2
    global_load_ushort v126, v2, s[18:19]
    v_lshrrev_b32 v1, 4, v0
    v_bfe_u32 v2, v0, 2, 2
    v_lshl_add_u32 v2, v1, 3, v2
    v_and_b32 v1, 3, v0
    v_lshlrev_b32 v1, 3, v1
    v_lshl_add_u32 v10, v2, 7, v1
    v_mov_b32 v11, v10
    v_add_u32 v10, s49, v10
    s_cmp_ge_u32 s46, 28
    s_cbranch_scc1 L_tp_noffn
    v_lshrrev_b32 v13, 3, v0
    s_movk_i32 s53, 3584
    v_mul_lo_u32 v13, s53, v13
    v_and_b32 v15, 7, v0
    v_lshl_add_u32 v13, v15, 4, v13
    s_mul_i32 s54, s3, 229376
    s_lshl_b32 s55, s46, 7
    s_add_u32 s54, s54, s55
    s_lshl_b32 s55, s46, 16
    s_and_b32 s56, s3, 1
    s_lshl_b32 s56, s56, 15
    s_add_u32 s55, s55, s56
    s_lshr_b32 s56, s3, 1
    s_lshl_b32 s56, s56, 8
    s_add_u32 s55, s55, s56
    s_waitcnt vmcnt(12)
    ds_read_b64_tr_b16 a[0:1], v10 offset:0
    ds_read_b64_tr_b16 a[2:3], v10 offset:512
    ds_read_b64_tr_b16 a[4:5], v10 offset:32
    ds_read_b64_tr_b16 a[6:7], v10 offset:544
    ds_read_b64_tr_b16 a[8:9], v10 offset:64
    ds_read_b64_tr_b16 a[10:11], v10 offset:576
    ds_read_b64_tr_b16 a[12:13], v10 offset:96
    ds_read_b64_tr_b16 a[14:15], v10 offset:608
    s_waitcnt lgkmcnt(0)
    s_mov_b32 s40, s16
    s_mov_b32 s41, s17
    s_mov_b32 s42, 0x1c0000
    s_mov_b32 s43, 0x20000
    s_add_u32 m0, s49, 0
    s_mov_b32 s53, s54
    buffer_load_dwordx4 v13, s[40:43], s53 offen offset:0 sc1 nt lds
    s_add_u32 s53, s53, 27648
    buffer_load_dwordx4 v13, s[40:43], s53 offen offset:1024 sc1 nt lds
    s_add_u32 s53, s53, 27648
    buffer_load_dwordx4 v13, s[40:43], s53 offen offset:2048 sc1 nt lds
    s_add_u32 s53, s53, 27648
    buffer_load_dwordx4 v13, s[40:43], s53 offen offset:3072 sc1 nt lds
    s_add_u32 s54, s54, 114688
    s_waitcnt vmcnt(12)
    ds_read_b64_tr_b16 a[16:17], v10 offset:4096
    ds_read_b64_tr_b16 a[18:19], v10 offset:4608
    ds_read_b64_tr_b16 a[20:21], v10 offset:4128
    ds_read_b64_tr_b16 a[22:23], v10 offset:4640
    ds_read_b64_tr_b16 a[24:25], v10 offset:4160
    ds_read_b64_tr_b16 a[26:27], v10 offset:4672
    ds_read_b64_tr_b16 a[28:29], v10 offset:4192
    ds_read_b64_tr_b16 a[30:31], v10 offset:4704
    s_waitcnt lgkmcnt(0)
    s_add_u32 m0, s49, 4096
    s_mov_b32 s53, s54
    buffer_load_dwordx4 v13, s[40:43], s53 offen offset:0 sc1 nt lds
    s_add_u32 s53, s53, 27648
    buffer_load_dwordx4 v13, s[40:43], s53 offen offset:1024 sc1 nt lds
    s_add_u32 s53, s53, 27648
    buffer_load_dwordx4 v13, s[40:43], s53 offen offset:2048 sc1 nt lds
    s_add_u32 s53, s53, 27648
    buffer_load_dwordx4 v13, s[40:43], s53 offen offset:3072 sc1 nt lds
    s_add_u32 s54, s54, 114688
    s_waitcnt vmcnt(12)
    ds_read_b64_tr_b16 a[32:33], v10 offset:8192
    ds_read_b64_tr_b16 a[34:35], v10 offset:8704
    ds_read_b64_tr_b16 a[36:37], v10 offset:8224
    ds_read_b64_tr_b16 a[38:39], v10 offset:8736
    ds_read_b64_tr_b16 a[40:41], v10 offset:8256
    ds_read_b64_tr_b16 a[42:43], v10 offset:8768
    ds_read_b64_tr_b16 a[44:45], v10 offset:8288
    ds_read_b64_tr_b16 a[46:47], v10 offset:8800
    s_waitcnt lgkmcnt(0)
    s_mov_b32 s40, s20
    s_mov_b32 s41, s21
    s_mov_b32 s42, 0x1c0000
    s_mov_b32 s43, 0x20000
    s_add_u32 m0, s49, 8192
    s_mov_b32 s53, s55
    buffer_load_dwordx4 v14, s[40:43], s53 offen offset:0 sc1 nt lds
    s_add_u32 s53, s53, 7168
    buffer_load_dwordx4 v14, s[40:43], s53 offen offset:1024 sc1 nt lds
    s_add_u32 s53, s53, 7168
    buffer_load_dwordx4 v14, s[40:43], s53 offen offset:2048 sc1 nt lds
    s_add_u32 s53, s53, 7168
    buffer_load_dwordx4 v14, s[40:43], s53 offen offset:3072 sc1 nt lds
    s_add_u32 s55, s55, 128
    s_waitcnt vmcnt(12)
    ds_read_b64_tr_b16 a[48:49], v10 offset:12288
    ds_read_b64_tr_b16 a[50:51], v10 offset:12800
    ds_read_b64_tr_b16 a[52:53], v10 offset:12320
    ds_read_b64_tr_b16 a[54:55], v10 offset:12832
    ds_read_b64_tr_b16 a[56:57], v10 offset:12352
    ds_read_b64_tr_b16 a[58:59], v10 offset:12864
    ds_read_b64_tr_b16 a[60:61], v10 offset:12384
    ds_read_b64_tr_b16 a[62:63], v10 offset:12896
    s_waitcnt lgkmcnt(0)
    s_add_u32 m0, s49, 12288
    s_mov_b32 s53, s55
    buffer_load_dwordx4 v14, s[40:43], s53 offen offset:0 sc1 nt lds
    s_add_u32 s53, s53, 7168
    buffer_load_dwordx4 v14, s[40:43], s53 offen offset:1024 sc1 nt lds
    s_add_u32 s53, s53, 7168
    buffer_load_dwordx4 v14, s[40:43], s53 offen offset:2048 sc1 nt lds
    s_add_u32 s53, s53, 7168
    buffer_load_dwordx4 v14, s[40:43], s53 offen offset:3072 sc1 nt lds
    s_add_u32 s55, s55, 128
    s_cmp_lg_u32 s3, 0
    s_cbranch_scc1 L_tq_skip_a
    s_and_b32 s54, s44, 7
    s_lshl_b32 s54, s54, 12
    s_add_u32 s53, s54, 4096
    v_lshl_add_u32 v111, v0, 4, s53
    s_lshr_b32 s54, s44, 3
    s_mul_i32 s54, s54, 0x02020202
    s_add_u32 s59, s54, 0x05040100
    s_mov_b32 s61, 0
    global_load_dwordx4 v[64:67], v111, s[28:29] offset:0 sc1
    global_load_dwordx4 v[68:71], v111, s[28:29] offset:1024 sc1
    global_load_dwordx4 v[72:75], v111, s[28:29] offset:2048 sc1
    global_load_dwordx4 v[76:79], v111, s[28:29] offset:3072 sc1
    s_waitcnt vmcnt(0)
    v_xor_b32 v96, s31, v65
    v_xor_b32 v97, s31, v67
    v_or_b32 v96, v96, v97
    v_xor_b32 v97, s31, v69
    v_or_b32 v96, v96, v97
    v_xor_b32 v97, s31, v71
    v_or_b32 v96, v96, v97
    v_xor_b32 v97, s31, v73
    v_or_b32 v96, v96, v97
    v_xor_b32 v97, s31, v75
    v_or_b32 v96, v96, v97
    v_xor_b32 v97, s31, v77
    v_or_b32 v96, v96, v97
    v_xor_b32 v97, s31, v79
    v_or_b32 v96, v96, v97
    v_cmp_ne_u32 vcc, 0, v96
    s_cbranch_vccz L_qok_a
L_qretry_a:
    global_load_dwordx4 v[64:67], v111, s[28:29] offset:0 sc1
    global_load_dwordx4 v[68:71], v111, s[28:29] offset:1024 sc1
    global_load_dwordx4 v[72:75], v111, s[28:29] offset:2048 sc1
    global_load_dwordx4 v[76:79], v111, s[28:29] offset:3072 sc1
    s_add_u32 s61, s61, 1
    s_cmp_gt_u32 s61, 400000
    s_cbranch_scc1 L_qok_a
    s_waitcnt vmcnt(0)
    v_xor_b32 v96, s31, v65
    v_xor_b32 v97, s31, v67
    v_or_b32 v96, v96, v97
    v_xor_b32 v97, s31, v69
    v_or_b32 v96, v96, v97
    v_xor_b32 v97, s31, v71
    v_or_b32 v96, v96, v97
    v_xor_b32 v97, s31, v73
    v_or_b32 v96, v96, v97
    v_xor_b32 v97, s31, v75
    v_or_b32 v96, v96, v97
    v_xor_b32 v97, s31, v77
    v_or_b32 v96, v96, v97
    v_xor_b32 v97, s31, v79
    v_or_b32 v96, v96, v97
    v_cmp_ne_u32 vcc, 0, v96
    s_cbranch_vccz L_qok_a
    s_branch L_qretry_a
L_qok_a:
    v_lshlrev_b32 v97, 2, v0
    v_add_u32 v97, 156672, v97
    v_perm_b32 v64, v66, v64, s59
    ds_write_b32 v97, v64 offset:0
    v_perm_b32 v68, v70, v68, s59
    ds_write_b32 v97, v68 offset:256
    v_perm_b32 v72, v74, v72, s59
    ds_write_b32 v97, v72 offset:512
    v_perm_b32 v76, v78, v76, s59
    ds_write_b32 v97, v76 offset:768
    s_waitcnt lgkmcnt(0)
L_tq_skip_a:
    s_waitcnt vmcnt(0)
    s_barrier
    s_cmp_ge_u32 s3, 4
    s_cbranch_scc1 L_tp_w2
    s_lshl_b32 s53, s3, 5
    v_add_u32 v11, s53, v11
    v_add_u32 v15, 0x10000, v11
    ds_read_b64_tr_b16 a[64:65], v11 offset:0
    ds_read_b64_tr_b16 a[66:67], v11 offset:512
    ds_read_b64_tr_b16 a[68:69], v11 offset:4096
    ds_read_b64_tr_b16 a[70:71], v11 offset:4608
    ds_read_b64_tr_b16 a[72:73], v11 offset:16384
    ds_read_b64_tr_b16 a[74:75], v11 offset:16896
    ds_read_b64_tr_b16 a[76:77], v11 offset:20480
    ds_read_b64_tr_b16 a[78:79], v11 offset:20992
    s_waitcnt lgkmcnt(0)
    ds_read_b64_tr_b16 a[80:81], v11 offset:32768
    ds_read_b64_tr_b16 a[82:83], v11 offset:33280
    ds_read_b64_tr_b16 a[84:85], v11 offset:36864
    ds_read_b64_tr_b16 a[86:87], v11 offset:37376
    ds_read_b64_tr_b16 a[88:89], v11 offset:49152
    ds_read_b64_tr_b16 a[90:91], v11 offset:49664
    ds_read_b64_tr_b16 a[92:93], v11 offset:53248
    ds_read_b64_tr_b16 a[94:95], v11 offset:53760
    s_waitcnt lgkmcnt(0)
    ds_read_b64_tr_b16 a[96:97], v15 offset:0
    ds_read_b64_tr_b16 a[98:99], v15 offset:512
    ds_read_b64_tr_b16 a[100:101], v15 offset:4096
    ds_read_b64_tr_b16 a[102:103], v15 offset:4608
    ds_read_b64_tr_b16 a[104:105], v15 offset:16384
    ds_read_b64_tr_b16 a[106:107], v15 offset:16896
    ds_read_b64_tr_b16 a[108:109], v15 offset:20480
    ds_read_b64_tr_b16 a[110:111], v15 offset:20992
    s_waitcnt lgkmcnt(0)
    ds_read_b64_tr_b16 a[112:113], v15 offset:32768
    ds_read_b64_tr_b16 a[114:115], v15 offset:33280
    ds_read_b64_tr_b16 a[116:117], v15 offset:36864
    ds_read_b64_tr_b16 a[118:119], v15 offset:37376
    ds_read_b64_tr_b16 a[120:121], v15 offset:49152
    ds_read_b64_tr_b16 a[122:123], v15 offset:49664
    ds_read_b64_tr_b16 a[124:125], v15 offset:53248
    ds_read_b64_tr_b16 a[126:127], v15 offset:53760
    s_waitcnt lgkmcnt(0)
    s_branch L_tp_rd
L_tp_w2:
    s_sub_u32 s53, s3, 4
    s_lshl_b32 s53, s53, 15
    v_add_u32 v11, s53, v11
    ds_read_b64_tr_b16 a[64:65], v11 offset:8192
    ds_read_b64_tr_b16 a[66:67], v11 offset:8704
    ds_read_b64_tr_b16 a[68:69], v11 offset:8224
    ds_read_b64_tr_b16 a[70:71], v11 offset:8736
    ds_read_b64_tr_b16 a[72:73], v11 offset:8256
    ds_read_b64_tr_b16 a[74:75], v11 offset:8768
    ds_read_b64_tr_b16 a[76:77], v11 offset:8288
    ds_read_b64_tr_b16 a[78:79], v11 offset:8800
    s_waitcnt lgkmcnt(0)
    ds_read_b64_tr_b16 a[80:81], v11 offset:12288
    ds_read_b64_tr_b16 a[82:83], v11 offset:12800
    ds_read_b64_tr_b16 a[84:85], v11 offset:12320
    ds_read_b64_tr_b16 a[86:87], v11 offset:12832
    ds_read_b64_tr_b16 a[88:89], v11 offset:12352
    ds_read_b64_tr_b16 a[90:91], v11 offset:12864
    ds_read_b64_tr_b16 a[92:93], v11 offset:12384
    ds_read_b64_tr_b16 a[94:95], v11 offset:12896
    s_waitcnt lgkmcnt(0)
    ds_read_b64_tr_b16 a[96:97], v11 offset:24576
    ds_read_b64_tr_b16 a[98:99], v11 offset:25088
    ds_read_b64_tr_b16 a[100:101], v11 offset:24608
    ds_read_b64_tr_b16 a[102:103], v11 offset:25120
    ds_read_b64_tr_b16 a[104:105], v11 offset:24640
    ds_read_b64_tr_b16 a[106:107], v11 offset:25152
    ds_read_b64_tr_b16 a[108:109], v11 offset:24672
    ds_read_b64_tr_b16 a[110:111], v11 offset:25184
    s_waitcnt lgkmcnt(0)
    ds_read_b64_tr_b16 a[112:113], v11 offset:28672
    ds_read_b64_tr_b16 a[114:115], v11 offset:29184
    ds_read_b64_tr_b16 a[116:117], v11 offset:28704
    ds_read_b64_tr_b16 a[118:119], v11 offset:29216
    ds_read_b64_tr_b16 a[120:121], v11 offset:28736
    ds_read_b64_tr_b16 a[122:123], v11 offset:29248
    ds_read_b64_tr_b16 a[124:125], v11 offset:28768
    ds_read_b64_tr_b16 a[126:127], v11 offset:29280
    s_waitcnt lgkmcnt(0)
L_tp_rd:
    s_barrier
    s_add_u32 m0, s49, 0
    s_nop 0
    buffer_load_dwordx4 v4, s[32:35], s50 offen offset:0 sc1 nt lds
    buffer_load_dwordx4 v5, s[32:35], s50 offen offset:1024 sc1 nt lds
    buffer_load_dwordx4 v6, s[32:35], s50 offen offset:2048 sc1 nt lds
    buffer_load_dwordx4 v7, s[32:35], s50 offen offset:3072 sc1 nt lds
    s_add_u32 m0, s49, 4096
    s_nop 0
    buffer_load_dwordx4 v8, s[36:39], s50 offen offset:0 sc1 nt lds
    buffer_load_dwordx4 v9, s[36:39], s50 offen offset:1024 sc1 nt lds
    buffer_load_dwordx4 v8, s[36:39], s50 offen offset:2048 sc1 nt lds
    buffer_load_dwordx4 v9, s[36:39], s50 offen offset:3072 sc1 nt lds
    s_add_u32 m0, s49, 8192
    s_nop 0
    buffer_load_dwordx4 v4, s[32:35], s51 offen offset:0 sc1 nt lds
    buffer_load_dwordx4 v5, s[32:35], s51 offen offset:1024 sc1 nt lds
    buffer_load_dwordx4 v6, s[32:35], s51 offen offset:2048 sc1 nt lds
    buffer_load_dwordx4 v7, s[32:35], s51 offen offset:3072 sc1 nt lds
    s_add_u32 m0, s49, 12288
    s_nop 0
    buffer_load_dwordx4 v8, s[36:39], s51 offen offset:0 sc1 nt lds
    buffer_load_dwordx4 v9, s[36:39], s51 offen offset:1024 sc1 nt lds
    buffer_load_dwordx4 v8, s[36:39], s51 offen offset:2048 sc1 nt lds
    buffer_load_dwordx4 v9, s[36:39], s51 offen offset:3072 sc1 nt lds
    s_branch L_tp_end
L_tp_noffn:
    s_cmp_lg_u32 s3, 0
    s_cbranch_scc1 L_tq_skip_b
    s_and_b32 s54, s44, 7
    s_lshl_b32 s54, s54, 12
    s_add_u32 s53, s54, 4096
    v_lshl_add_u32 v111, v0, 4, s53
    s_lshr_b32 s54, s44, 3
    s_mul_i32 s54, s54, 0x02020202
    s_add_u32 s59, s54, 0x05040100
    s_mov_b32 s61, 0
    global_load_dwordx4 v[64:67], v111, s[28:29] offset:0 sc1
    global_load_dwordx4 v[68:71], v111, s[28:29] offset:1024 sc1
    global_load_dwordx4 v[72:75], v111, s[28:29] offset:2048 sc1
    global_load_dwordx4 v[76:79], v111, s[28:29] offset:3072 sc1
    s_waitcnt vmcnt(0)
    v_xor_b32 v96, s31, v65
    v_xor_b32 v97, s31, v67
    v_or_b32 v96, v96, v97
    v_xor_b32 v97, s31, v69
    v_or_b32 v96, v96, v97
    v_xor_b32 v97, s31, v71
    v_or_b32 v96, v96, v97
    v_xor_b32 v97, s31, v73
    v_or_b32 v96, v96, v97
    v_xor_b32 v97, s31, v75
    v_or_b32 v96, v96, v97
    v_xor_b32 v97, s31, v77
    v_or_b32 v96, v96, v97
    v_xor_b32 v97, s31, v79
    v_or_b32 v96, v96, v97
    v_cmp_ne_u32 vcc, 0, v96
    s_cbranch_vccz L_qok_b
L_qretry_b:
    global_load_dwordx4 v[64:67], v111, s[28:29] offset:0 sc1
    global_load_dwordx4 v[68:71], v111, s[28:29] offset:1024 sc1
    global_load_dwordx4 v[72:75], v111, s[28:29] offset:2048 sc1
    global_load_dwordx4 v[76:79], v111, s[28:29] offset:3072 sc1
    s_add_u32 s61, s61, 1
    s_cmp_gt_u32 s61, 400000
    s_cbranch_scc1 L_qok_b
    s_waitcnt vmcnt(0)
    v_xor_b32 v96, s31, v65
    v_xor_b32 v97, s31, v67
    v_or_b32 v96, v96, v97
    v_xor_b32 v97, s31, v69
    v_or_b32 v96, v96, v97
    v_xor_b32 v97, s31, v71
    v_or_b32 v96, v96, v97
    v_xor_b32 v97, s31, v73
    v_or_b32 v96, v96, v97
    v_xor_b32 v97, s31, v75
    v_or_b32 v96, v96, v97
    v_xor_b32 v97, s31, v77
    v_or_b32 v96, v96, v97
    v_xor_b32 v97, s31, v79
    v_or_b32 v96, v96, v97
    v_cmp_ne_u32 vcc, 0, v96
    s_cbranch_vccz L_qok_b
    s_branch L_qretry_b
L_qok_b:
    v_lshlrev_b32 v97, 2, v0
    v_add_u32 v97, 156672, v97
    v_perm_b32 v64, v66, v64, s59
    ds_write_b32 v97, v64 offset:0
    v_perm_b32 v68, v70, v68, s59
    ds_write_b32 v97, v68 offset:256
    v_perm_b32 v72, v74, v72, s59
    ds_write_b32 v97, v72 offset:512
    v_perm_b32 v76, v78, v76, s59
    ds_write_b32 v97, v76 offset:768
    s_waitcnt lgkmcnt(0)
L_tq_skip_b:
    s_waitcnt vmcnt(0)
    ds_read_b64_tr_b16 a[0:1], v10 offset:0
    ds_read_b64_tr_b16 a[2:3], v10 offset:512
    ds_read_b64_tr_b16 a[4:5], v10 offset:32
    ds_read_b64_tr_b16 a[6:7], v10 offset:544
    ds_read_b64_tr_b16 a[8:9], v10 offset:64
    ds_read_b64_tr_b16 a[10:11], v10 offset:576
    ds_read_b64_tr_b16 a[12:13], v10 offset:96
    ds_read_b64_tr_b16 a[14:15], v10 offset:608
    s_waitcnt lgkmcnt(0)
    s_add_u32 m0, s49, 0
    s_nop 0
    buffer_load_dwordx4 v4, s[32:35], s50 offen offset:0 sc1 nt lds
    buffer_load_dwordx4 v5, s[32:35], s50 offen offset:1024 sc1 nt lds
    buffer_load_dwordx4 v6, s[32:35], s50 offen offset:2048 sc1 nt lds
    buffer_load_dwordx4 v7, s[32:35], s50 offen offset:3072 sc1 nt lds
    ds_read_b64_tr_b16 a[16:17], v10 offset:4096
    ds_read_b64_tr_b16 a[18:19], v10 offset:4608
    ds_read_b64_tr_b16 a[20:21], v10 offset:4128
    ds_read_b64_tr_b16 a[22:23], v10 offset:4640
    ds_read_b64_tr_b16 a[24:25], v10 offset:4160
    ds_read_b64_tr_b16 a[26:27], v10 offset:4672
    ds_read_b64_tr_b16 a[28:29], v10 offset:4192
    ds_read_b64_tr_b16 a[30:31], v10 offset:4704
    s_waitcnt lgkmcnt(0)
    s_add_u32 m0, s49, 4096
    s_nop 0
    buffer_load_dwordx4 v8, s[36:39], s50 offen offset:0 sc1 nt lds
    buffer_load_dwordx4 v9, s[36:39], s50 offen offset:1024 sc1 nt lds
    buffer_load_dwordx4 v8, s[36:39], s50 offen offset:2048 sc1 nt lds
    buffer_load_dwordx4 v9, s[36:39], s50 offen offset:3072 sc1 nt lds
    ds_read_b64_tr_b16 a[32:33], v10 offset:8192
    ds_read_b64_tr_b16 a[34:35], v10 offset:8704
    ds_read_b64_tr_b16 a[36:37], v10 offset:8224
    ds_read_b64_tr_b16 a[38:39], v10 offset:8736
    ds_read_b64_tr_b16 a[40:41], v10 offset:8256
    ds_read_b64_tr_b16 a[42:43], v10 offset:8768
    ds_read_b64_tr_b16 a[44:45], v10 offset:8288
    ds_read_b64_tr_b16 a[46:47], v10 offset:8800
    s_waitcnt lgkmcnt(0)
    s_add_u32 m0, s49, 8192
    s_nop 0
    buffer_load_dwordx4 v4, s[32:35], s51 offen offset:0 sc1 nt lds
    buffer_load_dwordx4 v5, s[32:35], s51 offen offset:1024 sc1 nt lds
    buffer_load_dwordx4 v6, s[32:35], s51 offen offset:2048 sc1 nt lds
    buffer_load_dwordx4 v7, s[32:35], s51 offen offset:3072 sc1 nt lds
    ds_read_b64_tr_b16 a[48:49], v10 offset:12288
    ds_read_b64_tr_b16 a[50:51], v10 offset:12800
    ds_read_b64_tr_b16 a[52:53], v10 offset:12320
    ds_read_b64_tr_b16 a[54:55], v10 offset:12832
    ds_read_b64_tr_b16 a[56:57], v10 offset:12352
    ds_read_b64_tr_b16 a[58:59], v10 offset:12864
    ds_read_b64_tr_b16 a[60:61], v10 offset:12384
    ds_read_b64_tr_b16 a[62:63], v10 offset:12896
    s_waitcnt lgkmcnt(0)
    s_add_u32 m0, s49, 12288
    s_nop 0
    buffer_load_dwordx4 v8, s[36:39], s51 offen offset:0 sc1 nt lds
    buffer_load_dwordx4 v9, s[36:39], s51 offen offset:1024 sc1 nt lds
    buffer_load_dwordx4 v8, s[36:39], s51 offen offset:2048 sc1 nt lds
    buffer_load_dwordx4 v9, s[36:39], s51 offen offset:3072 sc1 nt lds
L_tp_end:
    v_lshrrev_b32 v1, 4, v0
    v_and_b32 v2, 15, v0
    v_xor_b32 v10, v1, v2
    v_lshlrev_b32 v10, 4, v10
    v_lshl_add_u32 v10, v2, 8, v10
    v_add_u32 v112, s49, v10
    v_xor_b32 v113, 64, v112
    v_xor_b32 v114, 128, v112
    v_xor_b32 v115, 192, v112
    v_lshrrev_b32 v10, 2, v2
    v_lshl_add_u32 v10, v1, 2, v10
    v_and_b32 v11, 7, v10
    v_lshlrev_b32 v11, 5, v11
    v_lshl_add_u32 v11, v10, 8, v11
    v_and_b32 v10, 3, v2
    v_lshl_add_u32 v11, v10, 3, v11
    s_add_u32 s53, s49, 4096
    v_add_u32 v116, s53, v11
    v_xor_b32 v117, 32, v116
    v_xor_b32 v118, 64, v116
    v_xor_b32 v119, 96, v116
    v_xor_b32 v120, 128, v116
    v_xor_b32 v121, 160, v116
    v_xor_b32 v122, 192, v116
    v_xor_b32 v123, 224, v116
    v_mov_b32 v32, 0
    v_mov_b32 v33, 0
    v_mov_b32 v34, 0
    v_mov_b32 v35, 0
    v_mov_b32 v36, 0
    v_mov_b32 v37, 0
    v_mov_b32 v38, 0
    v_mov_b32 v39, 0
    v_mov_b32 v40, 0
    v_mov_b32 v41, 0
    v_mov_b32 v42, 0
    v_mov_b32 v43, 0
    v_mov_b32 v44, 0
    v_mov_b32 v45, 0
    v_mov_b32 v46, 0
    v_mov_b32 v47, 0
    v_mov_b32 v48, 0
    v_mov_b32 v49, 0
    v_mov_b32 v50, 0
    v_mov_b32 v51, 0
    v_mov_b32 v52, 0
    v_mov_b32 v53, 0
    v_mov_b32 v54, 0
    v_mov_b32 v55, 0
    v_mov_b32 v56, 0
    v_mov_b32 v57, 0
    v_mov_b32 v58, 0
    v_mov_b32 v59, 0
    v_mov_b32 v60, 0
    v_mov_b32 v61, 0
    v_mov_b32 v62, 0
    v_mov_b32 v63, 0
    v_mov_b32 v102, 0xff61b1e6
    v_mov_b32 v103, 0
    v_mul_f32 v104, s63, v102
    v_lshrrev_b32 v1, 4, v0
    v_and_b32 v2, 15, v0
    v_and_b32 v105, 3, v2
    v_mul_u32_u24 v10, 528, v105
    v_lshrrev_b32 v105, 2, v2
    v_lshl_add_u32 v10, v105, 6, v10
    v_lshl_add_u32 v10, v1, 4, v10
    s_mul_i32 s53, s3, 2112
    s_add_u32 s53, s53, 131072
    v_add_u32 v10, s53, v10
    v_lshlrev_b32 v11, 6, v2
    s_lshl_b32 s53, s3, 3
    s_add_u32 s53, s53, 157696
    v_add_u32 v11, s53, v11
    s_lshl_b32 s53, s101, 11
    s_add_u32 s53, s53, 65536
    v_lshl_add_u32 v12, v3, 2, s53
    s_lshr_b32 s53, s3, 1
    s_mul_i32 s53, s53, 528
    s_add_u32 s53, s53, 131072
    v_and_b32 v13, 127, v3
    v_lshl_add_u32 v13, v13, 2, s53
    s_and_b32 s53, s30, 0xff
    v_mov_b32 v14, s53
    s_movk_i32 s96, 0xff
    s_barrier
    s_cmp_lg_u32 s3, 0
    s_cbranch_scc1 L_pro_done
L_pro_done:
    v_lshrrev_b32 v1, 4, v0
    v_and_b32 v2, 3, v0
    v_lshlrev_b32 v2, 8, v2
    v_lshl_add_u32 v2, v1, 4, v2
    v_add_u32 v2, 156672, v2
    ds_read_b128 v[16:19], v2 offset:0
    ds_read_b128 v[20:23], v2 offset:64
    ds_read_b128 v[24:27], v2 offset:128
    ds_read_b128 v[28:31], v2 offset:192
    v_mov_b32 v127, 0
    s_waitcnt lgkmcnt(0)
L_loop_entry:
    v_mov_b32 v109, 158720
    s_lshl_b32 s53, s44, 7
    s_add_u32 s53, s53, 1015808
    v_mov_b32 v108, s53
    v_mov_b32 v107, 0
    v_mov_b32 v15, 0
    s_lshl_b32 s53, s44, 4
    v_mov_b32 v108, s53
    v_mov_b32 v15, 1
    s_mov_b32 s88, 0
    s_mov_b32 s89, 0
    s_mov_b32 s95, -1
    s_cmp_lg_u32 s3, 0
    s_cbranch_scc1 L_idinit
    ds_write_b32 v109, v15
L_idinit:
    s_waitcnt vmcnt(12)
    ds_read_b128 v[64:67], v112 offset:0
    ds_read_b128 v[68:71], v113 offset:0
    ds_read_b128 v[72:75], v114 offset:0
    ds_read_b128 v[76:79], v115 offset:0
    s_waitcnt lgkmcnt(0)
    s_barrier
    v_mfma_f32_16x16x32_bf16 v[96:99], v[64:67], v[16:19], 0
    v_mfma_f32_16x16x32_bf16 v[96:99], v[68:71], v[20:23], v[96:99]
    v_mfma_f32_16x16x32_bf16 v[96:99], v[72:75], v[24:27], v[96:99]
    v_mfma_f32_16x16x32_bf16 v[96:99], v[76:79], v[28:31], v[96:99]
    s_nop 7
    v_cvt_pk_bf16_f32 v105, v96, v97
    v_lshlrev_b32 v96, 16, v105
    v_and_b32 v97, 0xffff0000, v105
    v_mul_f32 v96, s92, v96
    v_mul_f32 v97, s92, v97
    v_cvt_pk_bf16_f32 v105, v96, v97
    v_lshlrev_b32 v96, 16, v105
    v_and_b32 v97, 0xffff0000, v105
    v_cvt_pk_bf16_f32 v105, v98, v99
    v_lshlrev_b32 v98, 16, v105
    v_and_b32 v99, 0xffff0000, v105
    v_mul_f32 v98, s92, v98
    v_mul_f32 v99, s92, v99
    v_cvt_pk_bf16_f32 v105, v98, v99
    v_lshlrev_b32 v98, 16, v105
    v_and_b32 v99, 0xffff0000, v105
    v_max3_f32 v105, v96, v97, v98
    v_max_f32 v105, v105, v99
    v_mov_b32 v106, v105
    s_nop 1
    v_permlane16_swap_b32 v105, v106
    v_max_f32 v105, v105, v106
    v_mov_b32 v106, v105
    s_nop 1
    v_permlane32_swap_b32 v105, v106
    v_max_f32 v105, v105, v106
    v_cmp_gt_f32 vcc, v105, v102
    s_cbranch_vccz L_norsp0
    v_max_f32 v105, v105, v102
    v_sub_f32 v106, v102, v105
    v_mul_f32 v106, s63, v106
    v_exp_f32 v106, v106
    v_mov_b32 v102, v105
    v_mul_f32 v104, s63, v105
    v_mul_f32 v103, v103, v106
    v_mul_f32 v32, v32, v106
    v_mul_f32 v33, v33, v106
    v_mul_f32 v34, v34, v106
    v_mul_f32 v35, v35, v106
    v_mul_f32 v36, v36, v106
    v_mul_f32 v37, v37, v106
    v_mul_f32 v38, v38, v106
    v_mul_f32 v39, v39, v106
    v_mul_f32 v40, v40, v106
    v_mul_f32 v41, v41, v106
    v_mul_f32 v42, v42, v106
    v_mul_f32 v43, v43, v106
    v_mul_f32 v44, v44, v106
    v_mul_f32 v45, v45, v106
    v_mul_f32 v46, v46, v106
    v_mul_f32 v47, v47, v106
    v_mul_f32 v48, v48, v106
    v_mul_f32 v49, v49, v106
    v_mul_f32 v50, v50, v106
    v_mul_f32 v51, v51, v106
    v_mul_f32 v52, v52, v106
    v_mul_f32 v53, v53, v106
    v_mul_f32 v54, v54, v106
    v_mul_f32 v55, v55, v106
    v_mul_f32 v56, v56, v106
    v_mul_f32 v57, v57, v106
    v_mul_f32 v58, v58, v106
    v_mul_f32 v59, v59, v106
    v_mul_f32 v60, v60, v106
    v_mul_f32 v61, v61, v106
    v_mul_f32 v62, v62, v106
    v_mul_f32 v63, v63, v106
L_norsp0:
    v_fma_f32 v96, v96, s63, -v104
    v_fma_f32 v97, v97, s63, -v104
    v_fma_f32 v98, v98, s63, -v104
    v_fma_f32 v99, v99, s63, -v104
    v_exp_f32 v96, v96
    v_exp_f32 v97, v97
    v_exp_f32 v98, v98
    v_exp_f32 v99, v99
    v_add_f32 v105, v96, v97
    v_add_f32 v106, v98, v99
    v_cvt_pk_bf16_f32 v100, v96, v97
    v_cvt_pk_bf16_f32 v101, v98, v99
    v_add_f32 v105, v105, v106
    v_add_f32 v103, v103, v105
    s_waitcnt vmcnt(8)
    ds_read_b64_tr_b16 v[80:81], v116 offset:0
    ds_read_b64_tr_b16 v[82:83], v117 offset:0
    ds_read_b64_tr_b16 v[84:85], v118 offset:0
    ds_read_b64_tr_b16 v[86:87], v119 offset:0
    ds_read_b64_tr_b16 v[88:89], v120 offset:0
    ds_read_b64_tr_b16 v[90:91], v121 offset:0
    ds_read_b64_tr_b16 v[92:93], v122 offset:0
    ds_read_b64_tr_b16 v[94:95], v123 offset:0
    s_waitcnt lgkmcnt(0)
    v_mfma_f32_16x16x16_bf16 v[32:35], v[80:81], v[100:101], v[32:35]
    v_mfma_f32_16x16x16_bf16 v[36:39], v[82:83], v[100:101], v[36:39]
    v_mfma_f32_16x16x16_bf16 v[40:43], v[84:85], v[100:101], v[40:43]
    v_mfma_f32_16x16x16_bf16 v[44:47], v[86:87], v[100:101], v[44:47]
    v_mfma_f32_16x16x16_bf16 v[48:51], v[88:89], v[100:101], v[48:51]
    v_mfma_f32_16x16x16_bf16 v[52:55], v[90:91], v[100:101], v[52:55]
    v_mfma_f32_16x16x16_bf16 v[56:59], v[92:93], v[100:101], v[56:59]
    v_mfma_f32_16x16x16_bf16 v[60:63], v[94:95], v[100:101], v[60:63]
    s_add_u32 s80, s80, 1
    s_branch L_loop_odd
L_loop:
L_top0:
    s_add_u32 s53, s80, 1
    s_cmp_lt_u32 s53, s81
    s_cbranch_scc1 L_nopub0
    s_cmp_lg_u32 s3, 0
    s_cbranch_scc1 L_nopub0
    s_cmp_eq_u32 s48, 0
    s_cselect_b32 s54, 0, 1
    s_add_u32 s54, s54, 0xfffe
    s_cmp_eq_u32 s88, 0
    s_cbranch_scc1 L_pubw0
    s_waitcnt vmcnt(8)
    v_readfirstlane_b32 s89, v107
    s_cmp_lg_u32 s95, -1
    s_cbranch_scc1 L_thr0
    s_lshr_b32 s54, s89, 1
    s_add_u32 s54, s54, 12
    s_cmp_ge_u32 s89, 8
    s_cselect_b32 s95, s54, 0
L_thr0:
    s_add_u32 s54, s89, 214
    s_min_u32 s54, s54, 0xfffe
L_pubw0:
    s_lshl_b32 s55, s53, 16
    s_or_b32 s54, s54, s55
    v_mov_b32 v105, s54
    ds_write_b32 v109, v105
L_nopub0:
    s_waitcnt vmcnt(4)
    s_add_u32 s53, s80, 1
    s_cmp_lt_u32 s53, s81
    s_cbranch_scc0 L_dyn0
    s_add_u32 s54, s82, s53
    s_branch L_gotid0
L_dyn0:
    s_mov_b32 s61, 0
L_idspin0:
    ds_read_b32 v110, v109
    s_add_u32 s61, s61, 1
    s_waitcnt lgkmcnt(0)
    v_readfirstlane_b32 s54, v110
    s_cmp_gt_u32 s61, 400000
    s_cbranch_scc1 L_idok0
    s_lshr_b32 s55, s54, 16
    s_cmp_lg_u32 s55, s53
    s_cbranch_scc1 L_idspin0
L_idok0:
    s_and_b32 s54, s54, 0xffff
L_gotid0:
    s_lshl_b32 s54, s54, 15
    s_add_u32 s51, s54, s84
    s_cmp_ge_u32 s51, s52
    s_cbranch_scc1 L_nok0
    s_mov_b32 s83, 1
    s_cmp_eq_u32 s80, s85
    s_cbranch_scc1 L_x10
    s_cmp_eq_u32 s80, s86
    s_cbranch_scc1 L_x20
    s_cmp_lt_u32 s80, s87
    s_cbranch_scc1 L_xnone0
    s_cmp_eq_u32 s80, s87
    s_cbranch_scc1 L_xfirst0
    s_cmp_eq_u32 s88, 0
    s_cbranch_scc1 L_xnone0
    s_mov_b32 s88, 0
    s_cmp_ge_u32 s89, 42
    s_cbranch_scc1 L_xnone0
    s_branch L_grab0
L_xfirst0:
    s_mov_b32 s61, 0
L_own0:
    v_readfirstlane_b32 s54, v15
    s_add_u32 s61, s61, 1
    s_cmp_lg_u32 s54, 0
    s_cbranch_scc1 L_grab0
    s_cmp_gt_u32 s61, 400000
    s_cbranch_scc1 L_grab0
    s_lshl_b32 s53, s44, 4
    s_add_u32 s53, s53, 1
    v_mov_b32 v106, s53
    global_load_ubyte v15, v106, s[26:27] sc1
    s_waitcnt vmcnt(0)
    s_branch L_own0
L_grab0:
    v_mov_b32 v105, 1
    s_mov_b64 exec, 1
    global_atomic_add v107, v108, v105, s[26:27] sc0 sc1
    s_mov_b64 exec, -1
    s_mov_b32 s88, 1
    s_branch L_xdone0
L_x10:
    s_or_b32 s53, s60, 0x80
    v_mov_b32 v105, s53
    v_mov_b32 v106, s2
    s_mov_b64 exec, 1
    global_store_byte v106, v105, s[26:27] sc1
    s_mov_b64 exec, -1
    s_branch L_xdone0
L_x20:
    s_lshl_b32 s53, s44, 4
    s_add_u32 s53, s53, 1
    v_mov_b32 v106, s53
    global_load_ubyte v15, v106, s[26:27] sc1
    s_branch L_xdone0
L_xnone0:
    s_mov_b32 s83, 0
L_xdone0:
    s_add_u32 m0, s49, 8192
    s_nop 0
    buffer_load_dwordx4 v4, s[32:35], s51 offen offset:0 sc1 nt lds
    buffer_load_dwordx4 v5, s[32:35], s51 offen offset:1024 sc1 nt lds
    buffer_load_dwordx4 v6, s[32:35], s51 offen offset:2048 sc1 nt lds
    buffer_load_dwordx4 v7, s[32:35], s51 offen offset:3072 sc1 nt lds
L_nok0:
    ds_read_b128 v[64:67], v112 offset:0
    ds_read_b128 v[68:71], v113 offset:0
    ds_read_b128 v[72:75], v114 offset:0
    ds_read_b128 v[76:79], v115 offset:0
    s_waitcnt lgkmcnt(0)
    s_barrier
    v_mfma_f32_16x16x32_bf16 v[96:99], v[64:67], v[16:19], 0
    v_mfma_f32_16x16x32_bf16 v[96:99], v[68:71], v[20:23], v[96:99]
    v_mfma_f32_16x16x32_bf16 v[96:99], v[72:75], v[24:27], v[96:99]
    v_mfma_f32_16x16x32_bf16 v[96:99], v[76:79], v[28:31], v[96:99]
    s_nop 7
    v_cvt_pk_bf16_f32 v105, v96, v97
    v_lshlrev_b32 v96, 16, v105
    v_and_b32 v97, 0xffff0000, v105
    v_mul_f32 v96, s92, v96
    v_mul_f32 v97, s92, v97
    v_cvt_pk_bf16_f32 v105, v96, v97
    v_lshlrev_b32 v96, 16, v105
    v_and_b32 v97, 0xffff0000, v105
    v_cvt_pk_bf16_f32 v105, v98, v99
    v_lshlrev_b32 v98, 16, v105
    v_and_b32 v99, 0xffff0000, v105
    v_mul_f32 v98, s92, v98
    v_mul_f32 v99, s92, v99
    v_cvt_pk_bf16_f32 v105, v98, v99
    v_lshlrev_b32 v98, 16, v105
    v_and_b32 v99, 0xffff0000, v105
    v_max3_f32 v105, v96, v97, v98
    v_max_f32 v105, v105, v99
    v_mov_b32 v106, v105
    s_nop 1
    v_permlane16_swap_b32 v105, v106
    v_max_f32 v105, v105, v106
    v_mov_b32 v106, v105
    s_nop 1
    v_permlane32_swap_b32 v105, v106
    v_max_f32 v105, v105, v106
    v_cmp_gt_f32 vcc, v105, v102
    s_cbranch_vccz L_nors0
    v_max_f32 v105, v105, v102
    v_sub_f32 v106, v102, v105
    v_mul_f32 v106, s63, v106
    v_exp_f32 v106, v106
    v_mov_b32 v102, v105
    v_mul_f32 v104, s63, v105
    v_mul_f32 v103, v103, v106
    v_mul_f32 v32, v32, v106
    v_mul_f32 v33, v33, v106
    v_mul_f32 v34, v34, v106
    v_mul_f32 v35, v35, v106
    v_mul_f32 v36, v36, v106
    v_mul_f32 v37, v37, v106
    v_mul_f32 v38, v38, v106
    v_mul_f32 v39, v39, v106
    v_mul_f32 v40, v40, v106
    v_mul_f32 v41, v41, v106
    v_mul_f32 v42, v42, v106
    v_mul_f32 v43, v43, v106
    v_mul_f32 v44, v44, v106
    v_mul_f32 v45, v45, v106
    v_mul_f32 v46, v46, v106
    v_mul_f32 v47, v47, v106
    v_mul_f32 v48, v48, v106
    v_mul_f32 v49, v49, v106
    v_mul_f32 v50, v50, v106
    v_mul_f32 v51, v51, v106
    v_mul_f32 v52, v52, v106
    v_mul_f32 v53, v53, v106
    v_mul_f32 v54, v54, v106
    v_mul_f32 v55, v55, v106
    v_mul_f32 v56, v56, v106
    v_mul_f32 v57, v57, v106
    v_mul_f32 v58, v58, v106
    v_mul_f32 v59, v59, v106
    v_mul_f32 v60, v60, v106
    v_mul_f32 v61, v61, v106
    v_mul_f32 v62, v62, v106
    v_mul_f32 v63, v63, v106
L_nors0:
    v_fma_f32 v96, v96, s63, -v104
    v_fma_f32 v97, v97, s63, -v104
    v_fma_f32 v98, v98, s63, -v104
    v_fma_f32 v99, v99, s63, -v104
    v_exp_f32 v96, v96
    v_exp_f32 v97, v97
    v_exp_f32 v98, v98
    v_exp_f32 v99, v99
    v_add_f32 v105, v96, v97
    v_add_f32 v106, v98, v99
    v_cvt_pk_bf16_f32 v100, v96, v97
    v_cvt_pk_bf16_f32 v101, v98, v99
    v_add_f32 v105, v105, v106
    v_add_f32 v103, v103, v105
    s_cmp_lt_u32 s51, s52
    s_cbranch_scc1 L_vmore0
    s_waitcnt vmcnt(0)
    s_branch L_vrd0
L_vmore0:
    s_cmp_lg_u32 s83, 0
    s_cbranch_scc1 L_vw0
    s_waitcnt vmcnt(4)
L_vw0:
    s_waitcnt vmcnt(5)
    s_add_u32 m0, s49, 12288
    s_nop 0
    buffer_load_dwordx4 v8, s[36:39], s51 offen offset:0 sc1 nt lds
    buffer_load_dwordx4 v9, s[36:39], s51 offen offset:1024 sc1 nt lds
    buffer_load_dwordx4 v8, s[36:39], s51 offen offset:2048 sc1 nt lds
    buffer_load_dwordx4 v9, s[36:39], s51 offen offset:3072 sc1 nt lds
L_vrd0:
    ds_read_b64_tr_b16 v[80:81], v116 offset:0
    ds_read_b64_tr_b16 v[82:83], v117 offset:0
    ds_read_b64_tr_b16 v[84:85], v118 offset:0
    ds_read_b64_tr_b16 v[86:87], v119 offset:0
    ds_read_b64_tr_b16 v[88:89], v120 offset:0
    ds_read_b64_tr_b16 v[90:91], v121 offset:0
    ds_read_b64_tr_b16 v[92:93], v122 offset:0
    ds_read_b64_tr_b16 v[94:95], v123 offset:0
    s_waitcnt lgkmcnt(0)
    v_mfma_f32_16x16x16_bf16 v[32:35], v[80:81], v[100:101], v[32:35]
    v_mfma_f32_16x16x16_bf16 v[36:39], v[82:83], v[100:101], v[36:39]
    v_mfma_f32_16x16x16_bf16 v[40:43], v[84:85], v[100:101], v[40:43]
    v_mfma_f32_16x16x16_bf16 v[44:47], v[86:87], v[100:101], v[44:47]
    v_mfma_f32_16x16x16_bf16 v[48:51], v[88:89], v[100:101], v[48:51]
    v_mfma_f32_16x16x16_bf16 v[52:55], v[90:91], v[100:101], v[52:55]
    v_mfma_f32_16x16x16_bf16 v[56:59], v[92:93], v[100:101], v[56:59]
    v_mfma_f32_16x16x16_bf16 v[60:63], v[94:95], v[100:101], v[60:63]
    s_add_u32 s80, s80, 1
    s_cmp_ge_u32 s51, s52
    s_cbranch_scc1 L_loop_done
L_loop_odd:
L_top1:
    s_add_u32 s53, s80, 1
    s_cmp_lt_u32 s53, s81
    s_cbranch_scc1 L_nopub1
    s_cmp_lg_u32 s3, 0
    s_cbranch_scc1 L_nopub1
    s_cmp_eq_u32 s48, 0
    s_cselect_b32 s54, 0, 1
    s_add_u32 s54, s54, 0xfffe
    s_cmp_eq_u32 s88, 0
    s_cbranch_scc1 L_pubw1
    s_waitcnt vmcnt(8)
    v_readfirstlane_b32 s89, v107
    s_cmp_lg_u32 s95, -1
    s_cbranch_scc1 L_thr1
    s_lshr_b32 s54, s89, 1
    s_add_u32 s54, s54, 12
    s_cmp_ge_u32 s89, 8
    s_cselect_b32 s95, s54, 0
L_thr1:
    s_add_u32 s54, s89, 214
    s_min_u32 s54, s54, 0xfffe
L_pubw1:
    s_lshl_b32 s55, s53, 16
    s_or_b32 s54, s54, s55
    v_mov_b32 v105, s54
    ds_write_b32 v109, v105
L_nopub1:
    s_waitcnt vmcnt(4)
    s_add_u32 s53, s80, 1
    s_cmp_lt_u32 s53, s81
    s_cbranch_scc0 L_dyn1
    s_add_u32 s54, s82, s53
    s_branch L_gotid1
L_dyn1:
    s_mov_b32 s61, 0
L_idspin1:
    ds_read_b32 v110, v109
    s_add_u32 s61, s61, 1
    s_waitcnt lgkmcnt(0)
    v_readfirstlane_b32 s54, v110
    s_cmp_gt_u32 s61, 400000
    s_cbranch_scc1 L_idok1
    s_lshr_b32 s55, s54, 16
    s_cmp_lg_u32 s55, s53
    s_cbranch_scc1 L_idspin1
L_idok1:
    s_and_b32 s54, s54, 0xffff
L_gotid1:
    s_lshl_b32 s54, s54, 15
    s_add_u32 s50, s54, s84
    s_cmp_ge_u32 s50, s52
    s_cbranch_scc1 L_nok1
    s_mov_b32 s83, 1
    s_cmp_eq_u32 s80, s85
    s_cbranch_scc1 L_x11
    s_cmp_eq_u32 s80, s86
    s_cbranch_scc1 L_x21
    s_cmp_lt_u32 s80, s87
    s_cbranch_scc1 L_xnone1
    s_cmp_eq_u32 s80, s87
    s_cbranch_scc1 L_xfirst1
    s_cmp_eq_u32 s88, 0
    s_cbranch_scc1 L_xnone1
    s_mov_b32 s88, 0
    s_cmp_ge_u32 s89, 42
    s_cbranch_scc1 L_xnone1
    s_branch L_grab1
L_xfirst1:
    s_mov_b32 s61, 0
L_own1:
    v_readfirstlane_b32 s54, v15
    s_add_u32 s61, s61, 1
    s_cmp_lg_u32 s54, 0
    s_cbranch_scc1 L_grab1
    s_cmp_gt_u32 s61, 400000
    s_cbranch_scc1 L_grab1
    s_lshl_b32 s53, s44, 4
    s_add_u32 s53, s53, 1
    v_mov_b32 v106, s53
    global_load_ubyte v15, v106, s[26:27] sc1
    s_waitcnt vmcnt(0)
    s_branch L_own1
L_grab1:
    v_mov_b32 v105, 1
    s_mov_b64 exec, 1
    global_atomic_add v107, v108, v105, s[26:27] sc0 sc1
    s_mov_b64 exec, -1
    s_mov_b32 s88, 1
    s_branch L_xdone1
L_x11:
    s_or_b32 s53, s60, 0x80
    v_mov_b32 v105, s53
    v_mov_b32 v106, s2
    s_mov_b64 exec, 1
    global_store_byte v106, v105, s[26:27] sc1
    s_mov_b64 exec, -1
    s_branch L_xdone1
L_x21:
    s_lshl_b32 s53, s44, 4
    s_add_u32 s53, s53, 1
    v_mov_b32 v106, s53
    global_load_ubyte v15, v106, s[26:27] sc1
    s_branch L_xdone1
L_xnone1:
    s_mov_b32 s83, 0
L_xdone1:
    s_add_u32 m0, s49, 0
    s_nop 0
    buffer_load_dwordx4 v4, s[32:35], s50 offen offset:0 sc1 nt lds
    buffer_load_dwordx4 v5, s[32:35], s50 offen offset:1024 sc1 nt lds
    buffer_load_dwordx4 v6, s[32:35], s50 offen offset:2048 sc1 nt lds
    buffer_load_dwordx4 v7, s[32:35], s50 offen offset:3072 sc1 nt lds
L_nok1:
    ds_read_b128 v[64:67], v112 offset:8192
    ds_read_b128 v[68:71], v113 offset:8192
    ds_read_b128 v[72:75], v114 offset:8192
    ds_read_b128 v[76:79], v115 offset:8192
    s_waitcnt lgkmcnt(0)
    s_barrier
    v_mfma_f32_16x16x32_bf16 v[96:99], v[64:67], v[16:19], 0
    v_mfma_f32_16x16x32_bf16 v[96:99], v[68:71], v[20:23], v[96:99]
    v_mfma_f32_16x16x32_bf16 v[96:99], v[72:75], v[24:27], v[96:99]
    v_mfma_f32_16x16x32_bf16 v[96:99], v[76:79], v[28:31], v[96:99]
    s_nop 7
    v_cvt_pk_bf16_f32 v105, v96, v97
    v_lshlrev_b32 v96, 16, v105
    v_and_b32 v97, 0xffff0000, v105
    v_mul_f32 v96, s92, v96
    v_mul_f32 v97, s92, v97
    v_cvt_pk_bf16_f32 v105, v96, v97
    v_lshlrev_b32 v96, 16, v105
    v_and_b32 v97, 0xffff0000, v105
    v_cvt_pk_bf16_f32 v105, v98, v99
    v_lshlrev_b32 v98, 16, v105
    v_and_b32 v99, 0xffff0000, v105
    v_mul_f32 v98, s92, v98
    v_mul_f32 v99, s92, v99
    v_cvt_pk_bf16_f32 v105, v98, v99
    v_lshlrev_b32 v98, 16, v105
    v_and_b32 v99, 0xffff0000, v105
    v_max3_f32 v105, v96, v97, v98
    v_max_f32 v105, v105, v99
    v_mov_b32 v106, v105
    s_nop 1
    v_permlane16_swap_b32 v105, v106
    v_max_f32 v105, v105, v106
    v_mov_b32 v106, v105
    s_nop 1
    v_permlane32_swap_b32 v105, v106
    v_max_f32 v105, v105, v106
    v_cmp_gt_f32 vcc, v105, v102
    s_cbranch_vccz L_nors1
    v_max_f32 v105, v105, v102
    v_sub_f32 v106, v102, v105
    v_mul_f32 v106, s63, v106
    v_exp_f32 v106, v106
    v_mov_b32 v102, v105
    v_mul_f32 v104, s63, v105
    v_mul_f32 v103, v103, v106
    v_mul_f32 v32, v32, v106
    v_mul_f32 v33, v33, v106
    v_mul_f32 v34, v34, v106
    v_mul_f32 v35, v35, v106
    v_mul_f32 v36, v36, v106
    v_mul_f32 v37, v37, v106
    v_mul_f32 v38, v38, v106
    v_mul_f32 v39, v39, v106
    v_mul_f32 v40, v40, v106
    v_mul_f32 v41, v41, v106
    v_mul_f32 v42, v42, v106
    v_mul_f32 v43, v43, v106
    v_mul_f32 v44, v44, v106
    v_mul_f32 v45, v45, v106
    v_mul_f32 v46, v46, v106
    v_mul_f32 v47, v47, v106
    v_mul_f32 v48, v48, v106
    v_mul_f32 v49, v49, v106
    v_mul_f32 v50, v50, v106
    v_mul_f32 v51, v51, v106
    v_mul_f32 v52, v52, v106
    v_mul_f32 v53, v53, v106
    v_mul_f32 v54, v54, v106
    v_mul_f32 v55, v55, v106
    v_mul_f32 v56, v56, v106
    v_mul_f32 v57, v57, v106
    v_mul_f32 v58, v58, v106
    v_mul_f32 v59, v59, v106
    v_mul_f32 v60, v60, v106
    v_mul_f32 v61, v61, v106
    v_mul_f32 v62, v62, v106
    v_mul_f32 v63, v63, v106
L_nors1:
    v_fma_f32 v96, v96, s63, -v104
    v_fma_f32 v97, v97, s63, -v104
    v_fma_f32 v98, v98, s63, -v104
    v_fma_f32 v99, v99, s63, -v104
    v_exp_f32 v96, v96
    v_exp_f32 v97, v97
    v_exp_f32 v98, v98
    v_exp_f32 v99, v99
    v_add_f32 v105, v96, v97
    v_add_f32 v106, v98, v99
    v_cvt_pk_bf16_f32 v100, v96, v97
    v_cvt_pk_bf16_f32 v101, v98, v99
    v_add_f32 v105, v105, v106
    v_add_f32 v103, v103, v105
    s_cmp_lt_u32 s50, s52
    s_cbranch_scc1 L_vmore1
    s_waitcnt vmcnt(0)
    s_branch L_vrd1
L_vmore1:
    s_cmp_lg_u32 s83, 0
    s_cbranch_scc1 L_vw1
    s_waitcnt vmcnt(4)
L_vw1:
    s_waitcnt vmcnt(5)
    s_add_u32 m0, s49, 4096
    s_nop 0
    buffer_load_dwordx4 v8, s[36:39], s50 offen offset:0 sc1 nt lds
    buffer_load_dwordx4 v9, s[36:39], s50 offen offset:1024 sc1 nt lds
    buffer_load_dwordx4 v8, s[36:39], s50 offen offset:2048 sc1 nt lds
    buffer_load_dwordx4 v9, s[36:39], s50 offen offset:3072 sc1 nt lds
L_vrd1:
    ds_read_b64_tr_b16 v[80:81], v116 offset:8192
    ds_read_b64_tr_b16 v[82:83], v117 offset:8192
    ds_read_b64_tr_b16 v[84:85], v118 offset:8192
    ds_read_b64_tr_b16 v[86:87], v119 offset:8192
    ds_read_b64_tr_b16 v[88:89], v120 offset:8192
    ds_read_b64_tr_b16 v[90:91], v121 offset:8192
    ds_read_b64_tr_b16 v[92:93], v122 offset:8192
    ds_read_b64_tr_b16 v[94:95], v123 offset:8192
    s_waitcnt lgkmcnt(0)
    v_mfma_f32_16x16x16_bf16 v[32:35], v[80:81], v[100:101], v[32:35]
    v_mfma_f32_16x16x16_bf16 v[36:39], v[82:83], v[100:101], v[36:39]
    v_mfma_f32_16x16x16_bf16 v[40:43], v[84:85], v[100:101], v[40:43]
    v_mfma_f32_16x16x16_bf16 v[44:47], v[86:87], v[100:101], v[44:47]
    v_mfma_f32_16x16x16_bf16 v[48:51], v[88:89], v[100:101], v[48:51]
    v_mfma_f32_16x16x16_bf16 v[52:55], v[90:91], v[100:101], v[52:55]
    v_mfma_f32_16x16x16_bf16 v[56:59], v[92:93], v[100:101], v[56:59]
    v_mfma_f32_16x16x16_bf16 v[60:63], v[94:95], v[100:101], v[60:63]
    s_add_u32 s80, s80, 1
    s_cmp_ge_u32 s50, s52
    s_cbranch_scc1 L_loop_done
    s_cmp_eq_u32 s97, 0
    s_cbranch_scc1 L_loop
    s_mov_b32 s97, 0
    v_mfma_f32_16x16x32_bf16 v[96:99], a[0:3], v[16:19], 0
    v_mfma_f32_16x16x32_bf16 v[96:99], a[4:7], v[20:23], v[96:99]
    v_mfma_f32_16x16x32_bf16 v[96:99], a[8:11], v[24:27], v[96:99]
    v_mfma_f32_16x16x32_bf16 v[96:99], a[12:15], v[28:31], v[96:99]
    s_nop 7
    v_cvt_pk_bf16_f32 v105, v96, v97
    v_lshlrev_b32 v96, 16, v105
    v_and_b32 v97, 0xffff0000, v105
    v_mul_f32 v96, s92, v96
    v_mul_f32 v97, s92, v97
    v_cvt_pk_bf16_f32 v105, v96, v97
    v_lshlrev_b32 v96, 16, v105
    v_and_b32 v97, 0xffff0000, v105
    v_cvt_pk_bf16_f32 v105, v98, v99
    v_lshlrev_b32 v98, 16, v105
    v_and_b32 v99, 0xffff0000, v105
    v_mul_f32 v98, s92, v98
    v_mul_f32 v99, s92, v99
    v_cvt_pk_bf16_f32 v105, v98, v99
    v_lshlrev_b32 v98, 16, v105
    v_and_b32 v99, 0xffff0000, v105
    v_max3_f32 v105, v96, v97, v98
    v_max_f32 v105, v105, v99
    v_mov_b32 v106, v105
    s_nop 1
    v_permlane16_swap_b32 v105, v106
    v_max_f32 v105, v105, v106
    v_mov_b32 v106, v105
    s_nop 1
    v_permlane32_swap_b32 v105, v106
    v_max_f32 v105, v105, v106
    v_cmp_gt_f32 vcc, v105, v102
    s_cbranch_vccz L_norsb0
    v_max_f32 v105, v105, v102
    v_sub_f32 v106, v102, v105
    v_mul_f32 v106, s63, v106
    v_exp_f32 v106, v106
    v_mov_b32 v102, v105
    v_mul_f32 v104, s63, v105
    v_mul_f32 v103, v103, v106
    v_mul_f32 v32, v32, v106
    v_mul_f32 v33, v33, v106
    v_mul_f32 v34, v34, v106
    v_mul_f32 v35, v35, v106
    v_mul_f32 v36, v36, v106
    v_mul_f32 v37, v37, v106
    v_mul_f32 v38, v38, v106
    v_mul_f32 v39, v39, v106
    v_mul_f32 v40, v40, v106
    v_mul_f32 v41, v41, v106
    v_mul_f32 v42, v42, v106
    v_mul_f32 v43, v43, v106
    v_mul_f32 v44, v44, v106
    v_mul_f32 v45, v45, v106
    v_mul_f32 v46, v46, v106
    v_mul_f32 v47, v47, v106
    v_mul_f32 v48, v48, v106
    v_mul_f32 v49, v49, v106
    v_mul_f32 v50, v50, v106
    v_mul_f32 v51, v51, v106
    v_mul_f32 v52, v52, v106
    v_mul_f32 v53, v53, v106
    v_mul_f32 v54, v54, v106
    v_mul_f32 v55, v55, v106
    v_mul_f32 v56, v56, v106
    v_mul_f32 v57, v57, v106
    v_mul_f32 v58, v58, v106
    v_mul_f32 v59, v59, v106
    v_mul_f32 v60, v60, v106
    v_mul_f32 v61, v61, v106
    v_mul_f32 v62, v62, v106
    v_mul_f32 v63, v63, v106
L_norsb0:
    v_fma_f32 v96, v96, s63, -v104
    v_fma_f32 v97, v97, s63, -v104
    v_fma_f32 v98, v98, s63, -v104
    v_fma_f32 v99, v99, s63, -v104
    v_exp_f32 v96, v96
    v_exp_f32 v97, v97
    v_exp_f32 v98, v98
    v_exp_f32 v99, v99
    v_add_f32 v105, v96, v97
    v_add_f32 v106, v98, v99
    v_cvt_pk_bf16_f32 v100, v96, v97
    v_cvt_pk_bf16_f32 v101, v98, v99
    v_add_f32 v105, v105, v106
    v_add_f32 v103, v103, v105
    s_waitcnt lgkmcnt(0)
    v_mfma_f32_16x16x16_bf16 v[32:35], a[16:17], v[100:101], v[32:35]
    v_mfma_f32_16x16x16_bf16 v[36:39], a[18:19], v[100:101], v[36:39]
    v_mfma_f32_16x16x16_bf16 v[40:43], a[20:21], v[100:101], v[40:43]
    v_mfma_f32_16x16x16_bf16 v[44:47], a[22:23], v[100:101], v[44:47]
    v_mfma_f32_16x16x16_bf16 v[48:51], a[24:25], v[100:101], v[48:51]
    v_mfma_f32_16x16x16_bf16 v[52:55], a[26:27], v[100:101], v[52:55]
    v_mfma_f32_16x16x16_bf16 v[56:59], a[28:29], v[100:101], v[56:59]
    v_mfma_f32_16x16x16_bf16 v[60:63], a[30:31], v[100:101], v[60:63]
    v_mfma_f32_16x16x32_bf16 v[96:99], a[32:35], v[16:19], 0
    v_mfma_f32_16x16x32_bf16 v[96:99], a[36:39], v[20:23], v[96:99]
    v_mfma_f32_16x16x32_bf16 v[96:99], a[40:43], v[24:27], v[96:99]
    v_mfma_f32_16x16x32_bf16 v[96:99], a[44:47], v[28:31], v[96:99]
    s_nop 7
    v_cvt_pk_bf16_f32 v105, v96, v97
    v_lshlrev_b32 v96, 16, v105
    v_and_b32 v97, 0xffff0000, v105
    v_mul_f32 v96, s92, v96
    v_mul_f32 v97, s92, v97
    v_cvt_pk_bf16_f32 v105, v96, v97
    v_lshlrev_b32 v96, 16, v105
    v_and_b32 v97, 0xffff0000, v105
    v_cvt_pk_bf16_f32 v105, v98, v99
    v_lshlrev_b32 v98, 16, v105
    v_and_b32 v99, 0xffff0000, v105
    v_mul_f32 v98, s92, v98
    v_mul_f32 v99, s92, v99
    v_cvt_pk_bf16_f32 v105, v98, v99
    v_lshlrev_b32 v98, 16, v105
    v_and_b32 v99, 0xffff0000, v105
    v_max3_f32 v105, v96, v97, v98
    v_max_f32 v105, v105, v99
    v_mov_b32 v106, v105
    s_nop 1
    v_permlane16_swap_b32 v105, v106
    v_max_f32 v105, v105, v106
    v_mov_b32 v106, v105
    s_nop 1
    v_permlane32_swap_b32 v105, v106
    v_max_f32 v105, v105, v106
    v_cmp_gt_f32 vcc, v105, v102
    s_cbranch_vccz L_norsb1
    v_max_f32 v105, v105, v102
    v_sub_f32 v106, v102, v105
    v_mul_f32 v106, s63, v106
    v_exp_f32 v106, v106
    v_mov_b32 v102, v105
    v_mul_f32 v104, s63, v105
    v_mul_f32 v103, v103, v106
    v_mul_f32 v32, v32, v106
    v_mul_f32 v33, v33, v106
    v_mul_f32 v34, v34, v106
    v_mul_f32 v35, v35, v106
    v_mul_f32 v36, v36, v106
    v_mul_f32 v37, v37, v106
    v_mul_f32 v38, v38, v106
    v_mul_f32 v39, v39, v106
    v_mul_f32 v40, v40, v106
    v_mul_f32 v41, v41, v106
    v_mul_f32 v42, v42, v106
    v_mul_f32 v43, v43, v106
    v_mul_f32 v44, v44, v106
    v_mul_f32 v45, v45, v106
    v_mul_f32 v46, v46, v106
    v_mul_f32 v47, v47, v106
    v_mul_f32 v48, v48, v106
    v_mul_f32 v49, v49, v106
    v_mul_f32 v50, v50, v106
    v_mul_f32 v51, v51, v106
    v_mul_f32 v52, v52, v106
    v_mul_f32 v53, v53, v106
    v_mul_f32 v54, v54, v106
    v_mul_f32 v55, v55, v106
    v_mul_f32 v56, v56, v106
    v_mul_f32 v57, v57, v106
    v_mul_f32 v58, v58, v106
    v_mul_f32 v59, v59, v106
    v_mul_f32 v60, v60, v106
    v_mul_f32 v61, v61, v106
    v_mul_f32 v62, v62, v106
    v_mul_f32 v63, v63, v106
L_norsb1:
    v_fma_f32 v96, v96, s63, -v104
    v_fma_f32 v97, v97, s63, -v104
    v_fma_f32 v98, v98, s63, -v104
    v_fma_f32 v99, v99, s63, -v104
    v_exp_f32 v96, v96
    v_exp_f32 v97, v97
    v_exp_f32 v98, v98
    v_exp_f32 v99, v99
    v_add_f32 v105, v96, v97
    v_add_f32 v106, v98, v99
    v_cvt_pk_bf16_f32 v100, v96, v97
    v_cvt_pk_bf16_f32 v101, v98, v99
    v_add_f32 v105, v105, v106
    v_add_f32 v103, v103, v105
    s_waitcnt lgkmcnt(0)
    v_mfma_f32_16x16x16_bf16 v[32:35], a[48:49], v[100:101], v[32:35]
    v_mfma_f32_16x16x16_bf16 v[36:39], a[50:51], v[100:101], v[36:39]
    v_mfma_f32_16x16x16_bf16 v[40:43], a[52:53], v[100:101], v[40:43]
    v_mfma_f32_16x16x16_bf16 v[44:47], a[54:55], v[100:101], v[44:47]
    v_mfma_f32_16x16x16_bf16 v[48:51], a[56:57], v[100:101], v[48:51]
    v_mfma_f32_16x16x16_bf16 v[52:55], a[58:59], v[100:101], v[52:55]
    v_mfma_f32_16x16x16_bf16 v[56:59], a[60:61], v[100:101], v[56:59]
    v_mfma_f32_16x16x16_bf16 v[60:63], a[62:63], v[100:101], v[60:63]
    s_branch L_loop
L_loop_done:
    s_cmp_lg_u32 s48, 0
    s_cbranch_scc1 L_nocpf
    s_getpc_b64 s[54:55]
L_cpf_pc:
    s_add_u32 s54, s54, L_tail_code-L_cpf_pc
    s_addc_u32 s55, s55, 0
    v_lshlrev_b32 v2, 4, v0
    s_lshl_b32 s53, s3, 10
    v_add_u32 v2, s53, v2
    v_min_u32 v2, L_end-L_tail_code-12, v2
    global_load_dwordx4 v[72:75], v2, s[54:55]
L_nocpf:
    s_cmp_lg_u32 s48, 0
    s_cbranch_scc1 L_noflagld
    v_and_b32 v2, 31, v0
    v_lshlrev_b32 v2, 2, v2
    v_add_u32 v2, 1019904, v2
    global_load_dword v127, v2, s[28:29] sc1
L_noflagld:
    v_mov_b32 v105, v103
    s_nop 1
    v_permlane16_swap_b32 v103, v105
    v_add_f32 v103, v103, v105
    v_mov_b32 v105, v103
    s_nop 1
    v_permlane32_swap_b32 v103, v105
    v_add_f32 v103, v103, v105
    v_mov_b32_dpp v32, v36 quad_perm:[0,1,2,3] row_mask:0xf bank_mask:0x2
    v_mov_b32_dpp v33, v37 quad_perm:[0,1,2,3] row_mask:0xf bank_mask:0x2
    v_mov_b32_dpp v34, v38 quad_perm:[0,1,2,3] row_mask:0xf bank_mask:0x2
    v_mov_b32_dpp v35, v39 quad_perm:[0,1,2,3] row_mask:0xf bank_mask:0x2
    v_mov_b32_dpp v32, v40 quad_perm:[0,1,2,3] row_mask:0xf bank_mask:0x4
    v_mov_b32_dpp v33, v41 quad_perm:[0,1,2,3] row_mask:0xf bank_mask:0x4
    v_mov_b32_dpp v34, v42 quad_perm:[0,1,2,3] row_mask:0xf bank_mask:0x4
    v_mov_b32_dpp v35, v43 quad_perm:[0,1,2,3] row_mask:0xf bank_mask:0x4
    v_mov_b32_dpp v32, v44 quad_perm:[0,1,2,3] row_mask:0xf bank_mask:0x8
    v_mov_b32_dpp v33, v45 quad_perm:[0,1,2,3] row_mask:0xf bank_mask:0x8
    v_mov_b32_dpp v34, v46 quad_perm:[0,1,2,3] row_mask:0xf bank_mask:0x8
    v_mov_b32_dpp v35, v47 quad_perm:[0,1,2,3] row_mask:0xf bank_mask:0x8
    ds_write_b128 v10, v[32:35] offset:0
    v_mov_b32_dpp v48, v52 quad_perm:[0,1,2,3] row_mask:0xf bank_mask:0x2
    v_mov_b32_dpp v49, v53 quad_perm:[0,1,2,3] row_mask:0xf bank_mask:0x2
    v_mov_b32_dpp v50, v54 quad_perm:[0,1,2,3] row_mask:0xf bank_mask:0x2
    v_mov_b32_dpp v51, v55 quad_perm:[0,1,2,3] row_mask:0xf bank_mask:0x2
    v_mov_b32_dpp v48, v56 quad_perm:[0,1,2,3] row_mask:0xf bank_mask:0x4
    v_mov_b32_dpp v49, v57 quad_perm:[0,1,2,3] row_mask:0xf bank_mask:0x4
    v_mov_b32_dpp v50, v58 quad_perm:[0,1,2,3] row_mask:0xf bank_mask:0x4
    v_mov_b32_dpp v51, v59 quad_perm:[0,1,2,3] row_mask:0xf bank_mask:0x4
    v_mov_b32_dpp v48, v60 quad_perm:[0,1,2,3] row_mask:0xf bank_mask:0x8
    v_mov_b32_dpp v49, v61 quad_perm:[0,1,2,3] row_mask:0xf bank_mask:0x8
    v_mov_b32_dpp v50, v62 quad_perm:[0,1,2,3] row_mask:0xf bank_mask:0x8
    v_mov_b32_dpp v51, v63 quad_perm:[0,1,2,3] row_mask:0xf bank_mask:0x8
    ds_write_b128 v10, v[48:51] offset:256
    s_mov_b64 exec, 0xf
    ds_write_b64 v11, v[102:103]
    s_mov_b64 exec, -1
    s_lshr_b32 s53, s3, 1
    s_lshl_b32 s54, s53, 6
    s_add_u32 s54, s54, 157696
    v_mov_b32 v10, s54
    s_lshl_b32 s54, s101, 7
    s_lshl_b32 s55, s53, 4
    s_add_u32 s54, s54, s55
    s_add_u32 s54, s54, 589824
    v_mov_b32 v11, s54
    s_waitcnt lgkmcnt(0)
    s_barrier
    ds_read_b128 v[16:19], v10 offset:0
    ds_read_b128 v[20:23], v10 offset:16
    ds_read_b128 v[24:27], v10 offset:32
    ds_read_b128 v[28:31], v10 offset:48
    ds_read_b32 v32, v13 offset:0
    ds_read_b32 v33, v13 offset:2112
    ds_read_b32 v34, v13 offset:4224
    ds_read_b32 v35, v13 offset:6336
    ds_read_b32 v36, v13 offset:8448
    ds_read_b32 v37, v13 offset:10560
    ds_read_b32 v38, v13 offset:12672
    ds_read_b32 v39, v13 offset:14784
    s_waitcnt lgkmcnt(8)
    v_max3_f32 v40, v16, v18, v20
    v_max3_f32 v40, v40, v22, v24
    v_max3_f32 v40, v40, v26, v28
    v_max_f32 v40, v40, v30
    v_mul_f32 v41, s63, v40
    v_fma_f32 v16, v16, s63, -v41
    v_fma_f32 v18, v18, s63, -v41
    v_fma_f32 v20, v20, s63, -v41
    v_fma_f32 v22, v22, s63, -v41
    v_fma_f32 v24, v24, s63, -v41
    v_fma_f32 v26, v26, s63, -v41
    v_fma_f32 v28, v28, s63, -v41
    v_fma_f32 v30, v30, s63, -v41
    v_exp_f32 v16, v16
    v_exp_f32 v18, v18
    v_exp_f32 v20, v20
    v_exp_f32 v22, v22
    v_exp_f32 v24, v24
    v_exp_f32 v26, v26
    v_exp_f32 v28, v28
    v_exp_f32 v30, v30
    s_waitcnt lgkmcnt(0)
    v_mul_f32 v42, v16, v32
    v_mul_f32 v43, v16, v17
    v_fmac_f32 v42, v18, v33
    v_fmac_f32 v43, v18, v19
    v_fmac_f32 v42, v20, v34
    v_fmac_f32 v43, v20, v21
    v_fmac_f32 v42, v22, v35
    v_fmac_f32 v43, v22, v23
    v_fmac_f32 v42, v24, v36
    v_fmac_f32 v43, v24, v25
    v_fmac_f32 v42, v26, v37
    v_fmac_f32 v43, v26, v27
    v_fmac_f32 v42, v28, v38
    v_fmac_f32 v43, v28, v29
    v_fmac_f32 v42, v30, v39
    v_fmac_f32 v43, v30, v31
    v_bfi_b32 v42, s96, v14, v42
    global_store_dword v12, v42, s[28:29] sc1
    v_mov_b32 v42, v41
    v_mov_b32 v44, s31
    s_and_b32 s54, s3, 1
    s_cmp_lg_u32 s54, 0
    s_cbranch_scc1 L_noml
    s_mov_b64 exec, 1
    global_store_dwordx3 v11, v[42:44], s[28:29] sc1
    s_mov_b64 exec, -1
L_noml:
    s_cmp_lg_u32 s48, 0
    s_cbranch_scc1 L_finish
L_tail_code:
    v_lshrrev_b32 v1, 3, v0
    v_and_b32 v2, 7, v0
    v_lshrrev_b32 v10, 4, v0
    v_and_b32 v11, 15, v0
    v_and_b32 v12, 1, v0
    s_lshr_b32 s53, s3, 2
    s_lshl_b32 s53, s53, 3
    s_lshr_b32 s54, s46, 2
    s_add_u32 s53, s53, s54
    s_lshl_b32 s53, s53, 4
    s_and_b32 s54, s46, 3
    s_lshl_b32 s55, s53, 11
    s_lshl_b32 s56, s54, 9
    s_add_u32 s55, s55, s56
    s_and_b32 s56, s3, 3
    s_lshl_b32 s56, s56, 7
    s_add_u32 s55, s55, s56
    s_add_u32 s55, s55, 65536
    v_lshlrev_b32 v13, 11, v1
    v_lshl_add_u32 v13, v2, 4, v13
    v_add_u32 v4, s55, v13
    v_add_u32 v5, 16384, v4
    s_lshl_b32 s55, s53, 7
    s_lshl_b32 s56, s54, 4
    s_add_u32 s55, s55, s56
    s_add_u32 s55, s55, 589824
    v_lshl_add_u32 v6, v11, 7, s55
    v_lshl_add_u32 v7, v1, 7, s55
    v_lshl_add_u32 v13, v2, 2, v10
    s_lshl_b32 s53, s3, 6
    s_add_u32 s53, s53, 157952
    v_lshl_add_u32 v8, v13, 1, s53
    v_lshlrev_b32 v13, 4, v10
    v_lshl_add_u32 v9, v12, 8, v13
    v_add_u32 v9, 157952, v9
    v_lshl_add_u32 v119, v12, 10, v13
    v_add_u32 v119, 147456, v119
    v_lshl_add_u32 v121, v12, 7, v13
    v_add_u32 v121, 158464, v121
    v_lshlrev_b32 v13, 3, v0
    s_lshl_b32 s53, s46, 12
    s_lshl_b32 s54, s3, 9
    s_add_u32 s54, s54, s53
    s_add_u32 s54, s54, 655360
    v_add_u32 v112, s54, v13
    s_and_b32 s54, s3, 3
    s_lshl_b32 s54, s54, 10
    s_add_u32 s54, s54, s53
    s_add_u32 s54, s54, 851968
    v_add_u32 v122, s54, v13
    v_lshlrev_b32 v13, 12, v1
    v_lshl_add_u32 v13, v2, 4, v13
    s_lshl_b32 s53, s46, 7
    s_add_u32 s54, s53, 655360
    v_add_u32 v113, s54, v13
    s_add_u32 s54, s53, 851968
    v_add_u32 v100, s54, v13
    v_add_u32 v114, 32768, v113
    v_add_u32 v115, 65536, v113
    v_add_u32 v116, 98304, v113
    v_add_u32 v101, 32768, v100
    v_add_u32 v102, 65536, v100
    v_and_b32 v13, 3, v1
    v_sub_u32 v13, v13, v1
    v_lshlrev_b32 v13, 12, v13
    v_add_u32 v13, v13, v100
    v_add_u32 v103, 98304, v13
    v_bfe_u32 v1, v0, 4, 1
    v_and_b32 v2, 7, v0
    v_lshrrev_b32 v13, 5, v0
    v_lshl_add_u32 v2, v2, 1, v13
    v_lshlrev_b32 v13, 2, v2
    v_lshl_add_u32 v13, v1, 6, v13
    s_add_u32 s54, s53, 786432
    v_add_u32 v117, s54, v13
    s_lshl_b32 s53, s46, 4
    v_add_u32 v2, s53, v2
    v_lshlrev_b32 v2, 1, v2
    v_lshl_add_u32 v123, v1, 10, v2
    v_lshlrev_b32 v118, 4, v0
    v_add_u32 v118, 786432, v118
    v_and_b32 v13, 1, v10
    v_lshlrev_b32 v13, 7, v13
    v_lshl_add_u32 v13, v11, 1, v13
    s_lshl_b32 s53, s3, 5
    s_add_u32 s53, s53, 158464
    v_add_u32 v120, s53, v13
    v_bfe_u32 v13, v0, 2, 1
    v_lshlrev_b32 v111, 10, v13
    v_lshrrev_b32 v13, 3, v0
    v_lshl_add_u32 v111, v13, 5, v111
    v_and_b32 v13, 3, v0
    v_lshl_add_u32 v111, v13, 3, v111
    v_add_u32 v111, 147456, v111
    s_mov_b32 s94, 0x00ff00ff
    s_mov_b32 s95, 0x00ff00ff
    v_lshlrev_b32 v124, 16, v124
    v_lshlrev_b32 v125, 16, v125
    v_lshlrev_b32 v126, 16, v126
    v_and_b32 v11, 31, v0
    v_lshlrev_b32 v11, 2, v11
    v_add_u32 v11, 1019904, v11
    s_mov_b32 s61, 0
    s_and_b32 s54, s3, 1
    s_cmp_eq_u32 s54, 0
    s_cbranch_scc1 L_flagw
    s_waitcnt vmcnt(1)
L_flagw:
    s_waitcnt vmcnt(2)
    s_and_b32 s53, s31, 0xfffffff0
L_flag:
    v_and_b32 v10, 0xfffffff0, v127
    v_cmp_ne_u32 vcc, s53, v10
    s_cbranch_vccz L_flag_ok
    global_load_dword v127, v11, s[28:29] sc1
    s_add_u32 s61, s61, 1
    s_cmp_gt_u32 s61, 400000
    s_cbranch_scc1 L_flag_ok
    s_waitcnt vmcnt(0)
    s_branch L_flag
L_flag_ok:
    v_and_b32 v10, 15, v127
    v_cmp_ne_u32 vcc, s60, v10
    s_nop 0
    s_cmp_lg_u64 vcc, 0
    s_cselect_b32 s62, 1, 0
    s_cmp_ge_u32 s3, 4
    s_cbranch_scc1 L_nowarm
    global_load_dwordx4 v[80:83], v118, s[28:29] offset:0 sc1
    global_load_dwordx4 v[84:87], v118, s[28:29] offset:1024 sc1
    global_load_dwordx4 v[88:91], v118, s[28:29] offset:2048 sc1
    global_load_dwordx4 v[92:95], v118, s[28:29] offset:3072 sc1
    s_cmp_lg_u32 s3, 0
    s_cbranch_scc1 L_nowarm
    global_load_dwordx4 v[48:51], v113, s[28:29] sc1
    global_load_dwordx4 v[64:67], v100, s[28:29] sc1
    global_load_dwordx4 v[52:55], v114, s[28:29] sc1
    global_load_dwordx4 v[68:71], v101, s[28:29] sc1
    global_load_dwordx4 v[56:59], v115, s[28:29] sc1
    global_load_dwordx4 v[72:75], v102, s[28:29] sc1
    global_load_dwordx4 v[60:63], v116, s[28:29] sc1
    global_load_dwordx4 v[76:79], v103, s[28:29] sc1
L_nowarm:
    s_mov_b32 s61, 0
L_h1:
    global_load_dwordx4 v[16:19], v4, s[28:29] sc1
    global_load_dwordx4 v[20:23], v5, s[28:29] sc1
    global_load_dwordx3 v[24:26], v6, s[28:29] sc1
    global_load_dwordx3 v[28:30], v7, s[28:29] sc1
    global_load_dwordx3 v[32:34], v7, s[28:29] offset:1024 sc1
    s_add_u32 s61, s61, 1
    s_waitcnt vmcnt(0)
    v_bitop3_b32 v36, v16, v17, v18 bitop3:0x80
    v_or3_b32 v37, v16, v17, v18
    v_bitop3_b32 v36, v36, v19, v20 bitop3:0x80
    v_or3_b32 v37, v37, v19, v20
    v_bitop3_b32 v36, v36, v21, v22 bitop3:0x80
    v_or3_b32 v37, v37, v21, v22
    v_bitop3_b32 v36, v36, v23, v23 bitop3:0x80
    v_or3_b32 v37, v37, v23, v23
    v_xor_b32 v36, v36, v14
    v_xor_b32 v37, v37, v14
    v_or_b32 v36, v36, v37
    v_and_b32 v36, 0xff, v36
    v_xor_b32 v37, s31, v26
    v_or_b32 v36, v36, v37
    v_xor_b32 v37, s31, v30
    v_or_b32 v36, v36, v37
    v_xor_b32 v37, s31, v34
    v_or_b32 v36, v36, v37
    v_cmp_ne_u32 vcc, 0, v36
    s_cmp_gt_u32 s61, 400000
    s_cbranch_scc1 L_h1_done
    s_and_b64 exec, exec, vcc
    s_cbranch_execnz L_h1
L_h1_done:
    s_mov_b64 exec, -1
    v_mov_b32 v36, v24
    s_nop 1
    v_max_f32_dpp v36, v36, v36 row_ror:8 row_mask:0xf bank_mask:0xf
    s_nop 1
    v_max_f32_dpp v36, v36, v36 row_ror:4 row_mask:0xf bank_mask:0xf
    s_nop 1
    v_max_f32_dpp v36, v36, v36 row_ror:2 row_mask:0xf bank_mask:0xf
    s_nop 1
    v_max_f32_dpp v36, v36, v36 row_ror:1 row_mask:0xf bank_mask:0xf
    v_sub_f32 v24, v24, v36
    v_sub_f32 v28, v28, v36
    v_sub_f32 v32, v32, v36
    v_exp_f32 v24, v24
    v_exp_f32 v28, v28
    v_exp_f32 v32, v32
    v_mul_f32 v24, v24, v25
    v_mul_f32 v16, v28, v16
    s_nop 0
    v_add_f32_dpp v24, v24, v24 row_ror:8 row_mask:0xf bank_mask:0xf
    v_mul_f32 v17, v28, v17
    s_nop 0
    v_add_f32_dpp v24, v24, v24 row_ror:4 row_mask:0xf bank_mask:0xf
    v_mul_f32 v18, v28, v18
    s_nop 0
    v_add_f32_dpp v24, v24, v24 row_ror:2 row_mask:0xf bank_mask:0xf
    v_mul_f32 v19, v28, v19
    s_nop 0
    v_add_f32_dpp v24, v24, v24 row_ror:1 row_mask:0xf bank_mask:0xf
    v_fmac_f32 v16, v32, v20
    v_fmac_f32 v17, v32, v21
    v_fmac_f32 v18, v32, v22
    v_fmac_f32 v19, v32, v23
    v_rcp_f32 v24, v24
    v_add_f32_dpp v16, v16, v16 row_ror:8 row_mask:0xf bank_mask:0xf
    v_add_f32_dpp v17, v17, v17 row_ror:8 row_mask:0xf bank_mask:0xf
    v_add_f32_dpp v18, v18, v18 row_ror:8 row_mask:0xf bank_mask:0xf
    v_add_f32_dpp v19, v19, v19 row_ror:8 row_mask:0xf bank_mask:0xf
    v_permlane16_swap_b32 v16, v17
    s_nop 0
    v_permlane16_swap_b32 v18, v19
    v_add_f32 v16, v16, v17
    v_add_f32 v18, v18, v19
    s_nop 1
    v_permlane32_swap_b32 v16, v18
    v_add_f32 v16, v16, v18
    v_mul_f32 v16, v16, v24
    v_cvt_pk_bf16_f32 v16, v16, v16
    ds_write_b16 v8, v16
    s_waitcnt lgkmcnt(0)
    s_barrier
    ds_read_b128 v[16:19], v9 offset:0
    ds_read_b128 v[20:23], v9 offset:64
    ds_read_b128 v[24:27], v9 offset:128
    ds_read_b128 v[28:31], v9 offset:192
    s_waitcnt lgkmcnt(3)
    v_mfma_f32_16x16x32_bf16 v[32:35], v[16:19], a[0:3], 0
    v_mfma_f32_16x16x32_bf16 v[36:39], v[16:19], a[4:7], 0
    v_mfma_f32_16x16x32_bf16 v[40:43], v[16:19], a[8:11], 0
    v_mfma_f32_16x16x32_bf16 v[44:47], v[16:19], a[12:15], 0
    s_waitcnt lgkmcnt(2)
    v_mfma_f32_16x16x32_bf16 v[32:35], v[20:23], a[16:19], v[32:35]
    v_mfma_f32_16x16x32_bf16 v[36:39], v[20:23], a[20:23], v[36:39]
    v_mfma_f32_16x16x32_bf16 v[40:43], v[20:23], a[24:27], v[40:43]
    v_mfma_f32_16x16x32_bf16 v[44:47], v[20:23], a[28:31], v[44:47]
    s_waitcnt lgkmcnt(1)
    v_mfma_f32_16x16x32_bf16 v[32:35], v[24:27], a[32:35], v[32:35]
    v_mfma_f32_16x16x32_bf16 v[36:39], v[24:27], a[36:39], v[36:39]
    v_mfma_f32_16x16x32_bf16 v[40:43], v[24:27], a[40:43], v[40:43]
    v_mfma_f32_16x16x32_bf16 v[44:47], v[24:27], a[44:47], v[44:47]
    s_waitcnt lgkmcnt(0)
    v_mfma_f32_16x16x32_bf16 v[32:35], v[28:31], a[48:51], v[32:35]
    v_mfma_f32_16x16x32_bf16 v[36:39], v[28:31], a[52:55], v[36:39]
    v_mfma_f32_16x16x32_bf16 v[40:43], v[28:31], a[56:59], v[40:43]
    v_mfma_f32_16x16x32_bf16 v[44:47], v[28:31], a[60:63], v[44:47]
    s_nop 5
    v_mov_b32_dpp v32, v36 quad_perm:[0,1,2,3] row_mask:0x2 bank_mask:0xf
    v_mov_b32_dpp v33, v37 quad_perm:[0,1,2,3] row_mask:0x2 bank_mask:0xf
    s_nop 0
    v_mov_b32_dpp v32, v40 quad_perm:[0,1,2,3] row_mask:0x4 bank_mask:0xf
    v_mov_b32_dpp v33, v41 quad_perm:[0,1,2,3] row_mask:0x4 bank_mask:0xf
    s_nop 0
    v_mov_b32_dpp v32, v44 quad_perm:[0,1,2,3] row_mask:0x8 bank_mask:0xf
    v_mov_b32_dpp v33, v45 quad_perm:[0,1,2,3] row_mask:0x8 bank_mask:0xf
    v_bfi_b32 v32, s96, v14, v32
    v_bfi_b32 v33, s96, v14, v33
    s_cmp_eq_u32 s62, 0
    s_cbranch_scc1 L_pl_h2
    global_store_dwordx2 v112, v[32:33], s[28:29] sc1
    s_branch L_pd_h2
L_pl_h2:
    global_store_dwordx2 v112, v[32:33], s[28:29]
L_pd_h2:
    s_cmp_lg_u32 s3, 0
    s_cbranch_scc1 L_h2_skip
    s_mov_b32 s61, 0
L_h2:
    global_load_dwordx4 v[16:19], v113, s[28:29] sc1
    global_load_dwordx4 v[20:23], v114, s[28:29] sc1
    global_load_dwordx4 v[24:27], v115, s[28:29] sc1
    global_load_dwordx4 v[28:31], v116, s[28:29] sc1
    s_add_u32 s61, s61, 1
    s_waitcnt vmcnt(0)
    v_bitop3_b32 v32, v16, v17, v18 bitop3:0x80
    v_or3_b32 v33, v16, v17, v18
    v_bitop3_b32 v32, v32, v19, v20 bitop3:0x80
    v_or3_b32 v33, v33, v19, v20
    v_bitop3_b32 v32, v32, v21, v22 bitop3:0x80
    v_or3_b32 v33, v33, v21, v22
    v_bitop3_b32 v32, v32, v23, v24 bitop3:0x80
    v_or3_b32 v33, v33, v23, v24
    v_bitop3_b32 v32, v32, v25, v26 bitop3:0x80
    v_or3_b32 v33, v33, v25, v26
    v_bitop3_b32 v32, v32, v27, v28 bitop3:0x80
    v_or3_b32 v33, v33, v27, v28
    v_bitop3_b32 v32, v32, v29, v30 bitop3:0x80
    v_or3_b32 v33, v33, v29, v30
    v_bitop3_b32 v32, v32, v31, v31 bitop3:0x80
    v_or3_b32 v33, v33, v31, v31
    v_xor_b32 v32, v32, v14
    v_xor_b32 v33, v33, v14
    v_or_b32 v32, v32, v33
    v_and_b32 v32, 0xff, v32
    v_cmp_ne_u32 vcc, 0, v32
    s_cmp_gt_u32 s61, 400000
    s_cbranch_scc1 L_h2_done
    s_and_b64 exec, exec, vcc
    s_cbranch_execnz L_h2
L_h2_done:
    s_mov_b64 exec, -1
    v_add_f32 v16, v16, v20
    v_add_f32 v24, v24, v28
    v_add_f32 v17, v17, v21
    v_add_f32 v25, v25, v29
    v_add_f32 v18, v18, v22
    v_add_f32 v26, v26, v30
    v_add_f32 v19, v19, v23
    v_add_f32 v27, v27, v31
    v_add_f32 v16, v16, v24
    v_add_f32 v17, v17, v25
    v_add_f32 v18, v18, v26
    v_add_f32 v19, v19, v27
    v_add_f32_dpp v16, v16, v16 row_ror:8 row_mask:0xf bank_mask:0xf
    v_add_f32_dpp v17, v17, v17 row_ror:8 row_mask:0xf bank_mask:0xf
    v_add_f32_dpp v18, v18, v18 row_ror:8 row_mask:0xf bank_mask:0xf
    v_add_f32_dpp v19, v19, v19 row_ror:8 row_mask:0xf bank_mask:0xf
    v_permlane16_swap_b32 v16, v17
    s_nop 0
    v_permlane16_swap_b32 v18, v19
    v_add_f32 v16, v16, v17
    v_add_f32 v18, v18, v19
    s_nop 1
    v_permlane32_swap_b32 v16, v18
    v_add_f32 v16, v16, v18
    v_cvt_pk_bf16_f32 v16, v16, v16
    v_and_b32 v16, 0xffff0000, v16
    v_add_f32 v16, v16, v124
    v_cvt_pk_bf16_f32 v124, v16, v16
    v_and_b32 v124, 0xffff0000, v124
    s_mov_b64 exec, s[94:95]
    v_bfi_b32 v17, s96, v14, v124
    s_cmp_eq_u32 s62, 0
    s_cbranch_scc1 L_pl_h3
    global_store_dword v117, v17, s[28:29] sc1
    s_branch L_pd_h3
L_pl_h3:
    global_store_dword v117, v17, s[28:29]
L_pd_h3:
    s_mov_b64 exec, -1
L_h2_skip:
    s_cmp_ge_u32 s46, 28
    s_cbranch_scc1 L_noffn
    s_barrier
    s_cmp_ge_u32 s3, 4
    s_cbranch_scc1 L_ffn2
    s_mov_b32 s61, 0
L_h3:
    global_load_dwordx4 v[80:83], v118, s[28:29] offset:0 sc1
    global_load_dwordx4 v[84:87], v118, s[28:29] offset:1024 sc1
    global_load_dwordx4 v[88:91], v118, s[28:29] offset:2048 sc1
    global_load_dwordx4 v[92:95], v118, s[28:29] offset:3072 sc1
    s_add_u32 s61, s61, 1
    s_waitcnt vmcnt(0)
    v_bitop3_b32 v32, v80, v81, v82 bitop3:0x80
    v_or3_b32 v33, v80, v81, v82
    v_bitop3_b32 v32, v32, v83, v84 bitop3:0x80
    v_or3_b32 v33, v33, v83, v84
    v_bitop3_b32 v32, v32, v85, v86 bitop3:0x80
    v_or3_b32 v33, v33, v85, v86
    v_bitop3_b32 v32, v32, v87, v88 bitop3:0x80
    v_or3_b32 v33, v33, v87, v88
    v_bitop3_b32 v32, v32, v89, v90 bitop3:0x80
    v_or3_b32 v33, v33, v89, v90
    v_bitop3_b32 v32, v32, v91, v92 bitop3:0x80
    v_or3_b32 v33, v33, v91, v92
    v_bitop3_b32 v32, v32, v93, v94 bitop3:0x80
    v_or3_b32 v33, v33, v93, v94
    v_bitop3_b32 v32, v32, v95, v95 bitop3:0x80
    v_or3_b32 v33, v33, v95, v95
    v_xor_b32 v32, v32, v14
    v_xor_b32 v33, v33, v14
    v_or_b32 v32, v32, v33
    v_and_b32 v32, 0xff, v32
    v_cmp_ne_u32 vcc, 0, v32
    s_cmp_gt_u32 s61, 400000
    s_cbranch_scc1 L_h3_done
    s_and_b64 exec, exec, vcc
    s_cbranch_execnz L_h3
L_h3_done:
    s_mov_b64 exec, -1
    v_pk_add_f32 v[104:105], v[80:81], v[82:83]
    v_pk_mul_f32 v[106:107], v[80:81], v[80:81]
    v_pk_fma_f32 v[106:107], v[82:83], v[82:83], v[106:107]
    v_pk_add_f32 v[104:105], v[104:105], v[84:85]
    v_pk_fma_f32 v[106:107], v[84:85], v[84:85], v[106:107]
    v_pk_add_f32 v[104:105], v[104:105], v[86:87]
    v_pk_fma_f32 v[106:107], v[86:87], v[86:87], v[106:107]
    v_pk_add_f32 v[104:105], v[104:105], v[88:89]
    v_pk_fma_f32 v[106:107], v[88:89], v[88:89], v[106:107]
    v_pk_add_f32 v[104:105], v[104:105], v[90:91]
    v_pk_fma_f32 v[106:107], v[90:91], v[90:91], v[106:107]
    v_pk_add_f32 v[104:105], v[104:105], v[92:93]
    v_pk_fma_f32 v[106:107], v[92:93], v[92:93], v[106:107]
    v_pk_add_f32 v[104:105], v[104:105], v[94:95]
    v_pk_fma_f32 v[106:107], v[94:95], v[94:95], v[106:107]
    v_add_f32 v104, v104, v105
    v_add_f32 v106, v106, v107
    s_nop 0
    v_add_f32_dpp v104, v104, v104 quad_perm:[1,0,3,2] row_mask:0xf bank_mask:0xf
    v_add_f32_dpp v106, v106, v106 quad_perm:[1,0,3,2] row_mask:0xf bank_mask:0xf
    s_nop 0
    v_add_f32_dpp v104, v104, v104 quad_perm:[2,3,0,1] row_mask:0xf bank_mask:0xf
    v_add_f32_dpp v106, v106, v106 quad_perm:[2,3,0,1] row_mask:0xf bank_mask:0xf
    s_nop 0
    v_add_f32_dpp v104, v104, v104 row_ror:8 row_mask:0xf bank_mask:0xf
    v_add_f32_dpp v106, v106, v106 row_ror:8 row_mask:0xf bank_mask:0xf
    v_mov_b32 v105, v104
    v_mov_b32 v107, v106
    s_nop 0
    v_permlane16_swap_b32 v104, v105
    v_permlane16_swap_b32 v106, v107
    v_add_f32 v104, v104, v105
    v_add_f32 v106, v106, v107
    v_mov_b32 v105, v104
    v_mov_b32 v107, v106
    s_nop 0
    v_permlane32_swap_b32 v104, v105
    v_permlane32_swap_b32 v106, v107
    v_add_f32 v104, v104, v105
    v_add_f32 v106, v106, v107
    v_mul_f32 v108, 0x3b000000, v104
    v_mul_f32 v106, 0x3b000000, v106
    v_fma_f32 v104, -v108, v108, v106
    v_max_f32 v104, 0, v104
    v_cvt_pk_bf16_f32 v104, v104, v104
    v_and_b32 v104, 0xffff0000, v104
    v_add_f32 v104, 0x3727c5ac, v104
    v_cvt_pk_bf16_f32 v104, v104, v104
    v_and_b32 v104, 0xffff0000, v104
    v_sqrt_f32 v104, v104
    v_cvt_pk_bf16_f32 v108, v108, v108
    v_and_b32 v108, 0xffff0000, v108
    v_cvt_pk_bf16_f32 v104, v104, v104
    v_and_b32 v104, 0xffff0000, v104
    v_rcp_f32 v104, v104
    v_pk_add_f32 v[80:81], v[80:81], v[108:109] op_sel_hi:[1,0] neg_lo:[0,1] neg_hi:[0,1]
    v_pk_add_f32 v[82:83], v[82:83], v[108:109] op_sel_hi:[1,0] neg_lo:[0,1] neg_hi:[0,1]
    v_pk_add_f32 v[84:85], v[84:85], v[108:109] op_sel_hi:[1,0] neg_lo:[0,1] neg_hi:[0,1]
    v_pk_add_f32 v[86:87], v[86:87], v[108:109] op_sel_hi:[1,0] neg_lo:[0,1] neg_hi:[0,1]
    v_pk_add_f32 v[88:89], v[88:89], v[108:109] op_sel_hi:[1,0] neg_lo:[0,1] neg_hi:[0,1]
    v_pk_add_f32 v[90:91], v[90:91], v[108:109] op_sel_hi:[1,0] neg_lo:[0,1] neg_hi:[0,1]
    v_pk_add_f32 v[92:93], v[92:93], v[108:109] op_sel_hi:[1,0] neg_lo:[0,1] neg_hi:[0,1]
    v_pk_add_f32 v[94:95], v[94:95], v[108:109] op_sel_hi:[1,0] neg_lo:[0,1] neg_hi:[0,1]
    v_cvt_pk_bf16_f32 v106, v80, v81
    v_and_b32 v81, 0xffff0000, v106
    v_lshlrev_b32 v80, 16, v106
    v_cvt_pk_bf16_f32 v106, v82, v83
    v_and_b32 v83, 0xffff0000, v106
    v_lshlrev_b32 v82, 16, v106
    v_cvt_pk_bf16_f32 v106, v84, v85
    v_and_b32 v85, 0xffff0000, v106
    v_lshlrev_b32 v84, 16, v106
    v_cvt_pk_bf16_f32 v106, v86, v87
    v_and_b32 v87, 0xffff0000, v106
    v_lshlrev_b32 v86, 16, v106
    v_cvt_pk_bf16_f32 v106, v88, v89
    v_and_b32 v89, 0xffff0000, v106
    v_lshlrev_b32 v88, 16, v106
    v_cvt_pk_bf16_f32 v106, v90, v91
    v_and_b32 v91, 0xffff0000, v106
    v_lshlrev_b32 v90, 16, v106
    v_cvt_pk_bf16_f32 v106, v92, v93
    v_and_b32 v93, 0xffff0000, v106
    v_lshlrev_b32 v92, 16, v106
    v_cvt_pk_bf16_f32 v106, v94, v95
    v_and_b32 v95, 0xffff0000, v106
    v_lshlrev_b32 v94, 16, v106
    v_pk_mul_f32 v[80:81], v[80:81], v[104:105] op_sel_hi:[1,0]
    v_pk_mul_f32 v[82:83], v[82:83], v[104:105] op_sel_hi:[1,0]
    v_pk_mul_f32 v[84:85], v[84:85], v[104:105] op_sel_hi:[1,0]
    v_pk_mul_f32 v[86:87], v[86:87], v[104:105] op_sel_hi:[1,0]
    v_pk_mul_f32 v[88:89], v[88:89], v[104:105] op_sel_hi:[1,0]
    v_pk_mul_f32 v[90:91], v[90:91], v[104:105] op_sel_hi:[1,0]
    v_pk_mul_f32 v[92:93], v[92:93], v[104:105] op_sel_hi:[1,0]
    v_pk_mul_f32 v[94:95], v[94:95], v[104:105] op_sel_hi:[1,0]
    v_cvt_pk_bf16_f32 v80, v80, v81
    v_cvt_pk_bf16_f32 v81, v82, v83
    ds_write_b64 v111, v[80:81] offset:0
    v_cvt_pk_bf16_f32 v84, v84, v85
    v_cvt_pk_bf16_f32 v85, v86, v87
    ds_write_b64 v111, v[84:85] offset:256
    v_cvt_pk_bf16_f32 v88, v88, v89
    v_cvt_pk_bf16_f32 v89, v90, v91
    ds_write_b64 v111, v[88:89] offset:512
    v_cvt_pk_bf16_f32 v92, v92, v93
    v_cvt_pk_bf16_f32 v93, v94, v95
    ds_write_b64 v111, v[92:93] offset:768
    s_waitcnt lgkmcnt(0)
    ds_read_b128 v[16:19], v119 offset:0
    ds_read_b128 v[20:23], v119 offset:64
    ds_read_b128 v[24:27], v119 offset:128
    ds_read_b128 v[28:31], v119 offset:192
    ds_read_b128 v[32:35], v119 offset:256
    ds_read_b128 v[36:39], v119 offset:320
    ds_read_b128 v[40:43], v119 offset:384
    ds_read_b128 v[44:47], v119 offset:448
    ds_read_b128 v[48:51], v119 offset:512
    ds_read_b128 v[52:55], v119 offset:576
    ds_read_b128 v[56:59], v119 offset:640
    ds_read_b128 v[60:63], v119 offset:704
    ds_read_b128 v[64:67], v119 offset:768
    ds_read_b128 v[68:71], v119 offset:832
    ds_read_b128 v[72:75], v119 offset:896
    ds_read_b128 v[76:79], v119 offset:960
    s_waitcnt lgkmcnt(14)
    v_mfma_f32_16x16x32_bf16 v[96:99], v[16:19], a[64:67], 0
    v_mfma_f32_16x16x32_bf16 v[96:99], v[20:23], a[68:71], v[96:99]
    s_waitcnt lgkmcnt(12)
    v_mfma_f32_16x16x32_bf16 v[96:99], v[24:27], a[72:75], v[96:99]
    v_mfma_f32_16x16x32_bf16 v[96:99], v[28:31], a[76:79], v[96:99]
    s_waitcnt lgkmcnt(10)
    v_mfma_f32_16x16x32_bf16 v[96:99], v[32:35], a[80:83], v[96:99]
    v_mfma_f32_16x16x32_bf16 v[96:99], v[36:39], a[84:87], v[96:99]
    s_waitcnt lgkmcnt(8)
    v_mfma_f32_16x16x32_bf16 v[96:99], v[40:43], a[88:91], v[96:99]
    v_mfma_f32_16x16x32_bf16 v[96:99], v[44:47], a[92:95], v[96:99]
    s_waitcnt lgkmcnt(6)
    v_mfma_f32_16x16x32_bf16 v[96:99], v[48:51], a[96:99], v[96:99]
    v_mfma_f32_16x16x32_bf16 v[96:99], v[52:55], a[100:103], v[96:99]
    s_waitcnt lgkmcnt(4)
    v_mfma_f32_16x16x32_bf16 v[96:99], v[56:59], a[104:107], v[96:99]
    v_mfma_f32_16x16x32_bf16 v[96:99], v[60:63], a[108:111], v[96:99]
    s_waitcnt lgkmcnt(2)
    v_mfma_f32_16x16x32_bf16 v[96:99], v[64:67], a[112:115], v[96:99]
    v_mfma_f32_16x16x32_bf16 v[96:99], v[68:71], a[116:119], v[96:99]
    s_waitcnt lgkmcnt(0)
    v_mfma_f32_16x16x32_bf16 v[96:99], v[72:75], a[120:123], v[96:99]
    v_mfma_f32_16x16x32_bf16 v[96:99], v[76:79], a[124:127], v[96:99]
    s_nop 7
    v_mov_b32_dpp v96, v97 quad_perm:[0,1,2,3] row_mask:0xa bank_mask:0xf
    v_cvt_pk_bf16_f32 v96, v96, v96
    v_and_b32 v96, 0xffff0000, v96
    v_add_f32 v96, v96, v126
    v_cvt_pk_bf16_f32 v96, v96, v96
    v_and_b32 v96, 0xffff0000, v96
    v_mul_f32 v97, v96, v96
    v_mul_f32 v97, 0xbdd2d3e8, v97
    v_add_f32 v97, 0xc0135761, v97
    v_mul_f32 v97, v97, v96
    v_exp_f32 v97, v97
    s_nop 0
    v_add_f32 v97, 1.0, v97
    v_rcp_f32 v97, v97
    s_nop 0
    v_mul_f32 v96, v96, v97
    v_cvt_pk_bf16_f32 v96, v96, v96
    ds_write_b16 v120, v96
    s_waitcnt lgkmcnt(0)
    s_barrier
    s_cmp_eq_u32 s3, 0
    s_cbranch_scc1 L_final
    s_branch L_finish
L_ffn2:
    s_barrier
    ds_read_b128 v[16:19], v121
    ds_read_b128 v[20:23], v121 offset:64
    s_waitcnt lgkmcnt(1)
    v_mfma_f32_16x16x32_bf16 v[32:35], v[16:19], a[64:67], 0
    v_mfma_f32_16x16x32_bf16 v[36:39], v[16:19], a[68:71], 0
    v_mfma_f32_16x16x32_bf16 v[40:43], v[16:19], a[72:75], 0
    v_mfma_f32_16x16x32_bf16 v[44:47], v[16:19], a[76:79], 0
    v_mfma_f32_16x16x32_bf16 v[48:51], v[16:19], a[80:83], 0
    v_mfma_f32_16x16x32_bf16 v[52:55], v[16:19], a[84:87], 0
    v_mfma_f32_16x16x32_bf16 v[56:59], v[16:19], a[88:91], 0
    v_mfma_f32_16x16x32_bf16 v[60:63], v[16:19], a[92:95], 0
    s_waitcnt lgkmcnt(0)
    v_mfma_f32_16x16x32_bf16 v[32:35], v[20:23], a[96:99], v[32:35]
    v_mfma_f32_16x16x32_bf16 v[36:39], v[20:23], a[100:103], v[36:39]
    v_mfma_f32_16x16x32_bf16 v[40:43], v[20:23], a[104:107], v[40:43]
    v_mfma_f32_16x16x32_bf16 v[44:47], v[20:23], a[108:111], v[44:47]
    v_mfma_f32_16x16x32_bf16 v[48:51], v[20:23], a[112:115], v[48:51]
    v_mfma_f32_16x16x32_bf16 v[52:55], v[20:23], a[116:119], v[52:55]
    v_mfma_f32_16x16x32_bf16 v[56:59], v[20:23], a[120:123], v[56:59]
    v_mfma_f32_16x16x32_bf16 v[60:63], v[20:23], a[124:127], v[60:63]
    s_nop 1
    v_mov_b32_dpp v32, v36 quad_perm:[0,1,2,3] row_mask:0x2 bank_mask:0xf
    v_mov_b32_dpp v33, v37 quad_perm:[0,1,2,3] row_mask:0x2 bank_mask:0xf
    s_nop 0
    v_mov_b32_dpp v32, v40 quad_perm:[0,1,2,3] row_mask:0x4 bank_mask:0xf
    v_mov_b32_dpp v33, v41 quad_perm:[0,1,2,3] row_mask:0x4 bank_mask:0xf
    s_nop 0
    v_mov_b32_dpp v32, v44 quad_perm:[0,1,2,3] row_mask:0x8 bank_mask:0xf
    v_mov_b32_dpp v33, v45 quad_perm:[0,1,2,3] row_mask:0x8 bank_mask:0xf
    v_mov_b32_dpp v48, v52 quad_perm:[0,1,2,3] row_mask:0x2 bank_mask:0xf
    v_mov_b32_dpp v49, v53 quad_perm:[0,1,2,3] row_mask:0x2 bank_mask:0xf
    s_nop 0
    v_mov_b32_dpp v48, v56 quad_perm:[0,1,2,3] row_mask:0x4 bank_mask:0xf
    v_mov_b32_dpp v49, v57 quad_perm:[0,1,2,3] row_mask:0x4 bank_mask:0xf
    s_nop 0
    v_mov_b32_dpp v48, v60 quad_perm:[0,1,2,3] row_mask:0x8 bank_mask:0xf
    v_mov_b32_dpp v49, v61 quad_perm:[0,1,2,3] row_mask:0x8 bank_mask:0xf
    v_bfi_b32 v32, s96, v14, v32
    v_bfi_b32 v33, s96, v14, v33
    v_bfi_b32 v48, s96, v14, v48
    v_bfi_b32 v49, s96, v14, v49
    s_cmp_eq_u32 s62, 0
    s_cbranch_scc1 L_pl_h4
    global_store_dwordx2 v122, v[32:33], s[28:29] offset:0 sc1
    global_store_dwordx2 v122, v[48:49], s[28:29] offset:512 sc1
    s_branch L_pd_h4
L_pl_h4:
    global_store_dwordx2 v122, v[32:33], s[28:29] offset:0
    global_store_dwordx2 v122, v[48:49], s[28:29] offset:512
L_pd_h4:
    s_branch L_finish
L_noffn:
    s_cmp_lg_u32 s3, 0
    s_cbranch_scc1 L_finish
L_final:
    s_mov_b32 s61, 0
L_h4:
    global_load_dwordx4 v[16:19], v100, s[28:29] sc1
    global_load_dwordx4 v[20:23], v101, s[28:29] sc1
    global_load_dwordx4 v[24:27], v102, s[28:29] sc1
    global_load_dwordx4 v[28:31], v103, s[28:29] sc1
    s_add_u32 s61, s61, 1
    s_waitcnt vmcnt(0)
    v_bitop3_b32 v32, v16, v17, v18 bitop3:0x80
    v_or3_b32 v33, v16, v17, v18
    v_bitop3_b32 v32, v32, v19, v20 bitop3:0x80
    v_or3_b32 v33, v33, v19, v20
    v_bitop3_b32 v32, v32, v21, v22 bitop3:0x80
    v_or3_b32 v33, v33, v21, v22
    v_bitop3_b32 v32, v32, v23, v24 bitop3:0x80
    v_or3_b32 v33, v33, v23, v24
    v_bitop3_b32 v32, v32, v25, v26 bitop3:0x80
    v_or3_b32 v33, v33, v25, v26
    v_bitop3_b32 v32, v32, v27, v28 bitop3:0x80
    v_or3_b32 v33, v33, v27, v28
    v_bitop3_b32 v32, v32, v29, v30 bitop3:0x80
    v_or3_b32 v33, v33, v29, v30
    v_bitop3_b32 v32, v32, v31, v31 bitop3:0x80
    v_or3_b32 v33, v33, v31, v31
    v_xor_b32 v32, v32, v14
    v_xor_b32 v33, v33, v14
    v_or_b32 v32, v32, v33
    v_and_b32 v32, 0xff, v32
    v_cmp_ne_u32 vcc, 0, v32
    s_cmp_gt_u32 s61, 400000
    s_cbranch_scc1 L_h4_done
    s_and_b64 exec, exec, vcc
    s_cbranch_execnz L_h4
L_h4_done:
    s_mov_b64 exec, -1
    s_mov_b32 exec_lo, 0
    s_mov_b32 exec_hi, -1
    v_mov_b32 v28, 0
    v_mov_b32 v29, 0
    v_mov_b32 v30, 0
    v_mov_b32 v31, 0
    s_mov_b64 exec, -1
    v_add_f32 v16, v16, v20
    v_add_f32 v24, v24, v28
    v_add_f32 v17, v17, v21
    v_add_f32 v25, v25, v29
    v_add_f32 v18, v18, v22
    v_add_f32 v26, v26, v30
    v_add_f32 v19, v19, v23
    v_add_f32 v27, v27, v31
    v_add_f32 v16, v16, v24
    v_add_f32 v17, v17, v25
    v_add_f32 v18, v18, v26
    v_add_f32 v19, v19, v27
    v_add_f32_dpp v16, v16, v16 row_ror:8 row_mask:0xf bank_mask:0xf
    v_add_f32_dpp v17, v17, v17 row_ror:8 row_mask:0xf bank_mask:0xf
    v_add_f32_dpp v18, v18, v18 row_ror:8 row_mask:0xf bank_mask:0xf
    v_add_f32_dpp v19, v19, v19 row_ror:8 row_mask:0xf bank_mask:0xf
    v_permlane16_swap_b32 v16, v17
    s_nop 0
    v_permlane16_swap_b32 v18, v19
    v_add_f32 v16, v16, v17
    v_add_f32 v18, v18, v19
    s_nop 1
    v_permlane32_swap_b32 v16, v18
    v_add_f32 v16, v16, v18
    v_cvt_pk_bf16_f32 v16, v16, v16
    v_and_b32 v16, 0xffff0000, v16
    v_add_f32 v16, v16, v125
    v_cvt_pk_bf16_f32 v16, v16, v16
    v_and_b32 v16, 0xffff0000, v16
    v_add_f32 v16, v16, v124
    v_cvt_pk_bf16_f32 v16, v16, v16
    s_mov_b64 exec, s[94:95]
    global_store_short v123, v16, s[24:25]
    s_mov_b64 exec, -1
    s_cmp_lg_u32 s2, 0
    s_cbranch_scc1 L_finish
    v_mov_b32 v10, 0
    v_mov_b32 v11, s30
    s_mov_b64 exec, 1
    global_store_dword v10, v11, s[28:29] sc1
    s_mov_b64 exec, -1
L_finish:
L_end:
    s_endpgm
.section .rodata,"a"
.p2align 6
.amdhsa_kernel sequential_preLN__gqa_block_cached__dense_activation_gelu__decode_kernel
  .amdhsa_next_free_vgpr 256
  .amdhsa_next_free_sgpr 102
  .amdhsa_accum_offset 128
  .amdhsa_group_segment_fixed_size 0
  .amdhsa_kernarg_size 104
  .amdhsa_user_sgpr_count 2
  .amdhsa_user_sgpr_kernarg_segment_ptr 1
  .amdhsa_system_sgpr_workgroup_id_x 1
.end_amdhsa_kernel
```
